```python
import torch

def _softmax(x, axis=-1):
    return torch.softmax(x, dim=axis)
def _gelu(x):
    return torch.nn.functional.gelu(x, approximate="tanh")
def _silu(x):
    return torch.nn.functional.silu(x)
def _sigmoid(x):
    return torch.sigmoid(x)
def _layernorm(x, axis=-1, eps=1e-5):
    m = x.mean(dim=axis, keepdim=True)
    v = x.var(dim=axis, keepdim=True, unbiased=False)
    return (x - m) / torch.sqrt(v + eps)
def _scatter_add(tgt, idx, src, axis=0):
    return tgt.clone().index_add_(axis, idx, src)
def _segment_sum(src, seg, n):
    out = torch.zeros((n,) + src.shape[1:], dtype=src.dtype)
    return out.index_add_(0, seg, src)
def _pad(x, pw):
    flat = tuple(v for pair in reversed(pw) for v in pair)
    return torch.nn.functional.pad(x, flat)

kernel_name = 'gather_scatter__cheap_equivariant_egnn__graph'

def setup_inputs():

    _w = (lambda a: (lambda t: t.to(torch.bfloat16) if t.is_floating_point() else t)(torch.as_tensor(a)))
    N, deg, D, De = 10000, 16, 256, max(4, 1)
    E = N * deg
    return {
        "h": _w((lambda *s: torch.randn(*s, dtype=torch.bfloat16) * 0.2)(N, D)),
        "pos": _w((lambda *s: torch.randn(*s, dtype=torch.bfloat16) * 0.4)(N, 3)),
        "e_attr": _w((lambda *s: torch.randn(*s, dtype=torch.bfloat16) * 0.4)(E, De)),
        "src": _w((lambda lo, hi, *s: torch.randint(lo, hi, s))(0, N, E).to(torch.int64)),
        "dst": _w((lambda lo, hi, *s: torch.randint(lo, hi, s))(0, N, E).to(torch.int64)),
        "w_e": _w(0.1 * (lambda *s: torch.randn(*s, dtype=torch.bfloat16) * 0.4)(2 * D + 1 + De, D)),
        "w_x": _w(0.1 * (lambda *s: torch.randn(*s, dtype=torch.bfloat16) * 0.2)(D, 1)),
        "w_h": _w(0.1 * (lambda *s: torch.randn(*s, dtype=torch.bfloat16) * 0.2)(2 * D, D)),
    }

def reference(h, pos, e_attr, src, dst, w_e, w_x, w_h):
    N, D = h.shape[0], h.shape[1]
    diff = pos[dst] - pos[src]
    dist2 = torch.sum(diff * diff, axis=-1, keepdims=True)
    e_in = torch.concatenate([h[dst], h[src], dist2, e_attr], axis=-1)
    m_ij = _silu(e_in @ w_e)
    coord_scale = m_ij @ w_x
    pos_new = pos + _segment_sum(diff * coord_scale, dst, N)
    m_i = _segment_sum(m_ij, dst, N)
    h_new = h + _silu(torch.concatenate([h, m_i], axis=-1) @ w_h)
    return h_new, pos_new
```

```asm
; @launch kernel=egnn_prep_kernel grid=(256,1,1) block=(896,1,1) lds=143360
; @launch kernel=gather_scatter__cheap_equivariant_egnn__graph_kernel grid=(256,1,1) block=(512,1,1) lds=160512
.amdgcn_target "amdgcn-amd-amdhsa--gfx950"
.text
.globl egnn_prep_kernel
.p2align 8
.type egnn_prep_kernel,@function
egnn_prep_kernel:
    s_cmp_ge_u32 s2, 256
    s_cbranch_scc1 K1_exit
    s_load_dwordx16 s[4:19], s[0:1], 0
    s_load_dwordx2 s[20:21], s[0:1], 80
    v_lshrrev_b32 v6, 6, v0
    v_and_b32 v1, 63, v0
    v_readfirstlane_b32 s36, v6
    s_and_b32 s39, s2, 7
    s_lshr_b32 s42, s2, 3
    s_and_b32 s38, s42, 1
    s_lshr_b32 s42, s42, 1
    s_lshl_b32 s42, s42, 3
    s_add_u32 s37, s42, s39
    s_cmp_ge_u32 s36, 4
    s_cbranch_scc1 K1_sort
    v_lshlrev_b32 v7, 2, v0
    v_mov_b32 v8, 0
    ds_write_b32 v7, v8
    s_cmp_ge_u32 s37, 125
    s_cbranch_scc1 K1_idle
    v_lshrrev_b32 v6, 4, v1
    v_and_b32 v7, 15, v1
    v_lshlrev_b32 v5, 2, v6
    v_xor_b32 v7, v7, v5
    v_lshlrev_b32 v7, 4, v7
    v_lshl_add_u32 v7, v6, 9, v7
    s_lshl_b32 s39, s36, 15
    s_lshl_b32 s42, s38, 8
    s_add_u32 s39, s39, s42
    s_add_u32 s39, s39, 131072
    v_add_u32 v5, s39, v7
    v_lshrrev_b32 v6, 5, v1
    v_and_b32 v7, 31, v1
    s_lshl_b32 s39, s36, 1
    v_add_u32 v8, s39, v6
    v_xor_b32 v9, v8, v7
    s_mul_i32 s42, s37, 80
    v_add_u32 v8, s42, v8
    v_lshlrev_b32 v8, 9, v8
    v_lshl_add_u32 v4, v9, 4, v8
    v_xor_b32 v18, 128, v4
    v_add_u32 v18, 4096, v18
    s_lshl_b32 s39, s36, 10
    s_add_u32 s39, s39, 36864
    s_lshl_b32 s42, s36, 14
    s_add_u32 s42, s42, 77824
    s_waitcnt lgkmcnt(0)
    s_add_u32 m0, s42, 0
    s_nop 0
    global_load_lds_dwordx4 v5, s[14:15]
    s_add_u32 m0, s42, 1024
    v_add_u32 v5, 2048, v5
    global_load_lds_dwordx4 v5, s[14:15]
    s_add_u32 m0, s42, 2048
    v_add_u32 v5, 2048, v5
    global_load_lds_dwordx4 v5, s[14:15]
    s_add_u32 m0, s42, 3072
    v_add_u32 v5, 2048, v5
    global_load_lds_dwordx4 v5, s[14:15]
    s_add_u32 m0, s42, 4096
    v_add_u32 v5, 2048, v5
    global_load_lds_dwordx4 v5, s[14:15]
    s_add_u32 m0, s42, 5120
    v_add_u32 v5, 2048, v5
    global_load_lds_dwordx4 v5, s[14:15]
    s_branch K1_gemm2
K1_sort:
    v_subrev_u32 v6, 256, v0
    v_cmp_gt_u32 vcc, 625, v6
    s_mul_i32 s39, s2, 625
    v_min_u32 v6, 624, v6
    v_add_u32 v6, s39, v6
    s_mov_b64 s[40:41], vcc
    v_lshlrev_b32 v7, 2, v6
    v_lshlrev_b32 v18, 3, v6
    s_mov_b32 s26, 60000
    s_mov_b32 s27, 0x20000
    s_lshl_b32 s45, s2, 1
    s_add_u32 s45, s45, s36
    s_sub_u32 s45, s45, 4
    s_cmp_ge_u32 s36, 6
    s_cselect_b32 s45, 1000, s45
    v_mov_b32 v9, 1
    s_waitcnt lgkmcnt(0)
    global_load_dword v2, v7, s[12:13]
    global_load_dword v3, v7, s[10:11]
    s_barrier
    s_mov_b32 s24, s6
    s_mov_b32 s25, s7
    v_lshlrev_b32 v8, 4, v1
    s_waitcnt vmcnt(0)
    v_mul_u32_u24 v14, 52429, v2
    v_mul_u32_u24 v7, 6, v3
    v_lshrrev_b32 v14, 21, v14
    v_mul_u32_u24 v15, 40, v14
    v_lshlrev_b32 v14, 2, v14
    s_mov_b64 exec, s[40:41]
    ds_add_rtn_u32 v16, v14, v9
    s_mov_b64 exec, -1
    v_and_b32 v7, -4, v7
    v_sub_u32 v15, v2, v15
    v_lshl_or_b32 v15, v3, 16, v15
    buffer_load_dwordx2 v[12:13], v7, s[24:27], 0 offen
    s_waitcnt lgkmcnt(0)
    s_barrier
    global_load_dwordx2 v[4:5], v18, s[8:9]
    ds_read_b128 v[44:47], v8 offset:0
    s_cmp_ge_u32 s45, 392
    s_cbranch_scc1 K1_notask
    s_cmp_lt_u32 s45, 128
    s_cselect_b32 s46, s14, s18
    s_cselect_b32 s47, s15, s19
    s_cmp_ge_u32 s45, 256
    s_cselect_b32 s39, 131072, 0
    s_and_b32 s42, s45, 15
    s_lshl_b32 s42, s42, 13
    s_add_u32 s39, s39, s42
    s_bfe_u32 s42, s45, 0x30004
    s_lshl_b32 s42, s42, 6
    s_add_u32 s39, s39, s42
    v_lshrrev_b32 v6, 5, v1
    v_and_b32 v7, 31, v1
    v_lshlrev_b32 v9, 12, v6
    s_cmp_lt_u32 s45, 384
    s_cbranch_scc1 K1_nokc
    v_lshlrev_b32 v9, 9, v6
    v_sub_u32 v9, 0, v9
    s_sub_u32 s39, s45, 384
    s_lshl_b32 s39, s39, 6
    s_add_u32 s39, s39, 260608
    s_mov_b32 s46, s14
    s_mov_b32 s47, s15
K1_nokc:
    v_lshl_add_u32 v7, v7, 1, v9
    v_add_u32 v7, s39, v7
    global_load_ushort v36, v7, s[46:47] offset:0
    global_load_ushort v37, v7, s[46:47] offset:512
    global_load_ushort v38, v7, s[46:47] offset:1024
    global_load_ushort v39, v7, s[46:47] offset:1536
    global_load_ushort v40, v7, s[46:47] offset:2048
    global_load_ushort v41, v7, s[46:47] offset:2560
    global_load_ushort v42, v7, s[46:47] offset:3072
    global_load_ushort v43, v7, s[46:47] offset:3584
K1_notask:
    s_waitcnt lgkmcnt(0)
    v_add3_u32 v48, v44, v45, v46
    v_add_u32 v48, v48, v47
    v_mov_b32 v49, v48
    s_nop 1
    v_add_u32_dpp v49, v49, v49 row_shr:1 row_mask:0xf bank_mask:0xf bound_ctrl:1
    s_nop 1
    v_add_u32_dpp v49, v49, v49 row_shr:2 row_mask:0xf bank_mask:0xf bound_ctrl:1
    s_nop 1
    v_add_u32_dpp v49, v49, v49 row_shr:4 row_mask:0xf bank_mask:0xf bound_ctrl:1
    s_nop 1
    v_add_u32_dpp v49, v49, v49 row_shr:8 row_mask:0xf bank_mask:0xf bound_ctrl:1
    s_nop 1
    v_add_u32_dpp v49, v49, v49 row_bcast:15 row_mask:0xa bank_mask:0xf
    s_nop 1
    v_add_u32_dpp v49, v49, v49 row_bcast:31 row_mask:0xc bank_mask:0xf
    v_sub_u32 v52, v49, v48
    v_add_u32 v53, v52, v44
    v_add_u32 v54, v53, v45
    v_add_u32 v55, v54, v46
    ds_write_b128 v8, v[52:55] offset:1024
    ds_read_b32 v14, v14 offset:1024
    v_subrev_u32 v6, 256, v0
    v_lshlrev_b32 v20, 4, v6
    s_mul_i32 s39, s2, 12544
    s_add_u32 s39, s39, 5242880
    v_add_u32 v21, s39, v20
    v_add_u32 v22, 10240, v21
    v_cmp_gt_u32 vcc, 144, v6
    v_subrev_u32 v6, 384, v0
    v_lshrrev_b32 v7, 4, v6
    v_and_b32 v6, 15, v6
    v_mul_u32_u24 v23, 272, v7
    v_lshl_add_u32 v23, v6, 4, v23
    v_lshlrev_b32 v7, 9, v7
    v_lshl_add_u32 v24, v6, 4, v7
    s_mul_i32 s39, s37, 40960
    s_lshl_b32 s42, s38, 8
    s_add_u32 s39, s39, s42
    s_add_u32 s39, s39, 4096
    v_add_u32 v24, s39, v24
    s_cmp_ge_u32 s37, 125
    s_cselect_b32 s43, 99, 6
    s_mov_b64 s[48:49], vcc
    v_and_b32 v7, 1, v3
    v_lshlrev_b32 v7, 4, v7
    s_waitcnt lgkmcnt(0)
    v_add_u32 v14, v14, v16
    v_mul_u32_u24 v14, 20, v14
    v_add_u32 v14, 2048, v14
    s_barrier
    s_barrier
    s_waitcnt vmcnt(0)
    s_cmp_lt_u32 s36, s43
    s_cbranch_scc1 K1_b0
    ds_read_b128 v[56:59], v23 offset:14848
    s_waitcnt lgkmcnt(0)
    global_store_dwordx4 v24, v[56:59], s[20:21] sc1
    v_add_u32 v24, 16384, v24
K1_b0:
    v_alignbit_b32 v12, v13, v12, v7
    v_lshrrev_b32 v13, v7, v13
    s_mov_b64 exec, s[40:41]
    ds_write2_b32 v14, v4, v5 offset0:0 offset1:1
    ds_write2_b32 v14, v12, v15 offset0:2 offset1:3
    ds_write_b32 v14, v13 offset:16
    s_mov_b64 exec, -1
    s_cmp_lg_u32 s36, 6
    s_cbranch_scc1 K1_nooff
    v_lshl_or_b32 v52, v44, 16, v52
    v_lshl_or_b32 v53, v45, 16, v53
    v_lshl_or_b32 v54, v46, 16, v54
    v_lshl_or_b32 v55, v47, 16, v55
    s_lshl_b32 s39, s2, 10
    s_add_u32 s39, s39, 8454144
    v_add_u32 v7, s39, v8
    global_store_dwordx4 v7, v[52:55], s[20:21] sc1
K1_nooff:
    s_cmp_ge_u32 s45, 392
    s_cbranch_scc1 K1_staged
    s_cmp_ge_u32 s45, 384
    s_cbranch_scc1 K1_kc
    v_lshl_or_b32 v36, v37, 16, v36
    v_lshl_or_b32 v37, v39, 16, v38
    v_lshl_or_b32 v38, v41, 16, v40
    v_lshl_or_b32 v39, v43, 16, v42
    s_lshl_b32 s39, s45, 10
    s_add_u32 s39, s39, 8716288
    v_add_u32 v6, s39, v8
    global_store_dwordx4 v6, v[36:39], s[20:21] sc1
K1_staged:
    s_waitcnt lgkmcnt(0)
    s_barrier
    s_cmp_lt_u32 s36, s43
    s_cbranch_scc1 K1_b1
    ds_read_b128 v[60:63], v23 offset:23552
    s_waitcnt lgkmcnt(0)
    global_store_dwordx4 v24, v[60:63], s[20:21] sc1
    v_add_u32 v24, 16384, v24
K1_b1:
    ds_read_b128 v[28:31], v20 offset:2048
    s_cmp_ge_u32 s36, 7
    s_cbranch_scc1 K1_r1
    ds_read_b128 v[32:35], v20 offset:12288
    s_mov_b64 exec, s[48:49]
    s_waitcnt lgkmcnt(0)
    global_store_dwordx4 v22, v[32:35], s[20:21] sc1
    s_mov_b64 exec, -1
K1_r1:
    s_waitcnt lgkmcnt(0)
    global_store_dwordx4 v21, v[28:31], s[20:21] sc1
    s_barrier
    s_cmp_lt_u32 s36, s43
    s_cbranch_scc1 K1_b2
    s_cmp_ge_u32 s36, 10
    s_cbranch_scc1 K1_b2
    ds_read_b128 v[64:67], v23 offset:32256
    s_waitcnt lgkmcnt(0)
    global_store_dwordx4 v24, v[64:67], s[20:21] sc1
    v_add_u32 v24, 16384, v24
K1_b2:
K1_done:
K1_exit:
    s_endpgm
K1_kc:
    v_cmp_gt_u32 vcc, 32, v1
    v_mov_b32 v7, 0xbfb8aa3b
    v_lshlrev_b32 v40, 16, v40
    v_lshlrev_b32 v41, 16, v41
    v_cndmask_b32_e64 v6, 0, v7, vcc
    v_lshlrev_b32 v42, 16, v42
    v_lshlrev_b32 v43, 16, v43
    v_mul_f32 v40, v7, v40
    v_mul_f32 v41, v6, v41
    v_mul_f32 v42, v6, v42
    v_mul_f32 v43, v6, v43
    v_cvt_pk_bf16_f32 v36, v40, v41
    v_cvt_pk_bf16_f32 v37, v42, v43
    s_sub_u32 s39, s45, 384
    s_lshl_b32 s39, s39, 9
    s_add_u32 s39, s39, 9109504
    v_lshl_add_u32 v6, v1, 3, s39
    global_store_dwordx2 v6, v[36:37], s[20:21] sc1
    s_branch K1_staged
K1_gemm2:
    s_getpc_b64 s[48:49]
K1_pc:
    s_sub_u32 s48, s48, K1_pc-egnn_prep_kernel
    s_subb_u32 s49, s49, 0
    v_lshlrev_b32 v91, 7, v0
    v_cmp_gt_u32 vcc, (K2_crest-egnn_prep_kernel)/128, v0
    s_and_saveexec_b64 s[50:51], vcc
    s_cbranch_execz K1_nopf
    global_load_dword v92, v91, s[48:49]
K1_nopf:
    s_mov_b64 exec, s[50:51]
    s_barrier
    s_add_u32 m0, s42, 6144
    v_add_u32 v5, 2048, v5
    global_load_lds_dwordx4 v5, s[14:15]
    s_add_u32 m0, s42, 7168
    v_add_u32 v5, 2048, v5
    global_load_lds_dwordx4 v5, s[14:15]
    s_add_u32 m0, s42, 8192
    v_add_u32 v5, 2048, v5
    global_load_lds_dwordx4 v5, s[14:15]
    s_add_u32 m0, s42, 9216
    v_add_u32 v5, 2048, v5
    global_load_lds_dwordx4 v5, s[14:15]
    s_add_u32 m0, s42, 10240
    v_add_u32 v5, 2048, v5
    global_load_lds_dwordx4 v5, s[14:15]
    s_add_u32 m0, s42, 11264
    v_add_u32 v5, 2048, v5
    global_load_lds_dwordx4 v5, s[14:15]
    s_add_u32 m0, s42, 12288
    v_add_u32 v5, 2048, v5
    global_load_lds_dwordx4 v5, s[14:15]
    s_add_u32 m0, s42, 13312
    v_add_u32 v5, 2048, v5
    global_load_lds_dwordx4 v5, s[14:15]
    s_add_u32 m0, s42, 14336
    v_add_u32 v5, 2048, v5
    global_load_lds_dwordx4 v5, s[14:15]
    s_add_u32 m0, s42, 15360
    v_add_u32 v5, 2048, v5
    global_load_lds_dwordx4 v5, s[14:15]
    s_add_u32 m0, s39, 0
    s_nop 0
    global_load_lds_dwordx4 v4, s[4:5]
    s_add_u32 m0, s39, 4096
    s_nop 0
    global_load_lds_dwordx4 v18, s[4:5]
    s_add_u32 m0, s39, 8192
    v_add_u32 v4, 8192, v4
    global_load_lds_dwordx4 v4, s[4:5]
    s_add_u32 m0, s39, 12288
    v_add_u32 v18, 8192, v18
    global_load_lds_dwordx4 v18, s[4:5]
    s_add_u32 m0, s39, 16384
    v_add_u32 v4, 8192, v4
    global_load_lds_dwordx4 v4, s[4:5]
    s_add_u32 m0, s39, 20480
    v_add_u32 v18, 8192, v18
    global_load_lds_dwordx4 v18, s[4:5]
    s_add_u32 m0, s39, 24576
    v_add_u32 v4, 8192, v4
    global_load_lds_dwordx4 v4, s[4:5]
    s_add_u32 m0, s39, 28672
    v_add_u32 v18, 8192, v18
    global_load_lds_dwordx4 v18, s[4:5]
    s_add_u32 m0, s39, 32768
    v_add_u32 v4, 8192, v4
    global_load_lds_dwordx4 v4, s[4:5]
    s_add_u32 m0, s39, 36864
    v_add_u32 v18, 8192, v18
    global_load_lds_dwordx4 v18, s[4:5]
    v_bfe_u32 v6, v1, 2, 2
    v_lshrrev_b32 v7, 5, v1
    v_lshl_add_u32 v8, v7, 3, v6
    v_lshlrev_b32 v2, 8, v8
    v_bfe_u32 v8, v1, 4, 1
    v_bfe_u32 v9, v1, 1, 1
    v_lshl_add_u32 v8, v8, 1, v9
    s_lshl_b32 s43, s36, 2
    v_add_u32 v8, s43, v8
    v_lshlrev_b32 v6, 2, v6
    v_xor_b32 v8, v8, v6
    v_lshl_add_u32 v2, v8, 4, v2
    v_and_b32 v8, 1, v1
    v_lshl_add_u32 v2, v8, 3, v2
    v_add_u32 v2, 77824, v2
    v_and_b32 v6, 31, v1
    v_and_b32 v8, 15, v1
    v_xor_b32 v8, v8, v7
    v_lshlrev_b32 v8, 4, v8
    v_lshl_add_u32 v8, v6, 9, v8
    v_add_u32 v10, 36864, v8
    v_xor_b32 v11, 32, v10
    v_xor_b32 v12, 64, v10
    v_xor_b32 v13, 96, v10
    v_xor_b32 v14, 128, v10
    v_xor_b32 v15, 160, v10
    v_xor_b32 v16, 192, v10
    v_xor_b32 v17, 224, v10
    v_mul_u32_u24 v6, 272, v6
    s_lshl_b32 s43, s36, 6
    s_add_u32 s43, s43, 14848
    v_lshl_add_u32 v7, v7, 3, s43
    v_add_u32 v3, v6, v7
    s_mov_b32 s46, 0xbfb8aa3b
    s_waitcnt vmcnt(6)
    s_barrier
    ds_read_b64_tr_b16 v[20:21], v2 offset:0
    ds_read_b64_tr_b16 v[22:23], v2 offset:1024
    ds_read_b128 v[84:87], v10 offset:0
    ds_read_b64_tr_b16 v[24:25], v2 offset:4096
    ds_read_b64_tr_b16 v[26:27], v2 offset:5120
    ds_read_b128 v[88:91], v11 offset:0
    s_waitcnt  lgkmcnt(3)
    v_mfma_f32_32x32x16_bf16 v[96:111], v[20:23], v[84:87], 0
    ds_read_b64_tr_b16 v[28:29], v2 offset:8192
    ds_read_b64_tr_b16 v[30:31], v2 offset:9216
    ds_read_b128 v[92:95], v12 offset:0
    s_waitcnt  lgkmcnt(3)
    v_mfma_f32_32x32x16_bf16 v[96:111], v[24:27], v[88:91], v[96:111]
    ds_read_b64_tr_b16 v[32:33], v2 offset:12288
    ds_read_b64_tr_b16 v[34:35], v2 offset:13312
    ds_read_b128 v[84:87], v13 offset:0
    s_waitcnt  lgkmcnt(3)
    v_mfma_f32_32x32x16_bf16 v[96:111], v[28:31], v[92:95], v[96:111]
    ds_read_b64_tr_b16 v[36:37], v2 offset:16384
    ds_read_b64_tr_b16 v[38:39], v2 offset:17408
    ds_read_b128 v[88:91], v14 offset:0
    s_waitcnt  lgkmcnt(3)
    v_mfma_f32_32x32x16_bf16 v[96:111], v[32:35], v[84:87], v[96:111]
    ds_read_b64_tr_b16 v[40:41], v2 offset:20480
    ds_read_b64_tr_b16 v[42:43], v2 offset:21504
    ds_read_b128 v[92:95], v15 offset:0
    s_waitcnt  lgkmcnt(3)
    v_mfma_f32_32x32x16_bf16 v[96:111], v[36:39], v[88:91], v[96:111]
    ds_read_b64_tr_b16 v[44:45], v2 offset:24576
    ds_read_b64_tr_b16 v[46:47], v2 offset:25600
    ds_read_b128 v[84:87], v16 offset:0
    s_waitcnt  lgkmcnt(3)
    v_mfma_f32_32x32x16_bf16 v[96:111], v[40:43], v[92:95], v[96:111]
    ds_read_b64_tr_b16 v[48:49], v2 offset:28672
    ds_read_b64_tr_b16 v[50:51], v2 offset:29696
    ds_read_b128 v[88:91], v17 offset:0
    s_waitcnt  lgkmcnt(3)
    v_mfma_f32_32x32x16_bf16 v[96:111], v[44:47], v[84:87], v[96:111]
    ds_read_b64_tr_b16 v[52:53], v2 offset:32768
    ds_read_b64_tr_b16 v[54:55], v2 offset:33792
    ds_read_b128 v[92:95], v10 offset:256
    s_waitcnt  lgkmcnt(3)
    v_mfma_f32_32x32x16_bf16 v[96:111], v[48:51], v[88:91], v[96:111]
    ds_read_b64_tr_b16 v[56:57], v2 offset:36864
    ds_read_b64_tr_b16 v[58:59], v2 offset:37888
    ds_read_b128 v[84:87], v11 offset:256
    s_waitcnt  lgkmcnt(3)
    v_mfma_f32_32x32x16_bf16 v[96:111], v[52:55], v[92:95], v[96:111]
    ds_read_b64_tr_b16 v[60:61], v2 offset:40960
    ds_read_b64_tr_b16 v[62:63], v2 offset:41984
    ds_read_b128 v[88:91], v12 offset:256
    s_waitcnt  lgkmcnt(3)
    v_mfma_f32_32x32x16_bf16 v[96:111], v[56:59], v[84:87], v[96:111]
    ds_read_b64_tr_b16 v[64:65], v2 offset:45056
    ds_read_b64_tr_b16 v[66:67], v2 offset:46080
    ds_read_b128 v[92:95], v13 offset:256
    s_waitcnt  lgkmcnt(3)
    v_mfma_f32_32x32x16_bf16 v[96:111], v[60:63], v[88:91], v[96:111]
    ds_read_b64_tr_b16 v[68:69], v2 offset:49152
    ds_read_b64_tr_b16 v[70:71], v2 offset:50176
    ds_read_b128 v[84:87], v14 offset:256
    s_waitcnt  lgkmcnt(3)
    v_mfma_f32_32x32x16_bf16 v[96:111], v[64:67], v[92:95], v[96:111]
    ds_read_b64_tr_b16 v[72:73], v2 offset:53248
    ds_read_b64_tr_b16 v[74:75], v2 offset:54272
    ds_read_b128 v[88:91], v15 offset:256
    s_waitcnt  lgkmcnt(3)
    v_mfma_f32_32x32x16_bf16 v[96:111], v[68:71], v[84:87], v[96:111]
    ds_read_b64_tr_b16 v[76:77], v2 offset:57344
    ds_read_b64_tr_b16 v[78:79], v2 offset:58368
    ds_read_b128 v[92:95], v16 offset:256
    s_waitcnt  lgkmcnt(3)
    v_mfma_f32_32x32x16_bf16 v[96:111], v[72:75], v[88:91], v[96:111]
    s_waitcnt vmcnt(2)
    s_barrier
    ds_read_b64_tr_b16 v[80:81], v2 offset:61440
    ds_read_b64_tr_b16 v[82:83], v2 offset:62464
    ds_read_b128 v[84:87], v17 offset:256
    s_waitcnt  lgkmcnt(3)
    v_mfma_f32_32x32x16_bf16 v[96:111], v[76:79], v[92:95], v[96:111]
    ds_read_b128 v[88:91], v10 offset:16384
    s_waitcnt  lgkmcnt(1)
    v_mfma_f32_32x32x16_bf16 v[96:111], v[80:83], v[84:87], v[96:111]
    ds_read_b128 v[92:95], v11 offset:16384
    s_waitcnt  lgkmcnt(1)
    v_mfma_f32_32x32x16_bf16 v[112:127], v[20:23], v[88:91], 0
    ds_read_b128 v[84:87], v12 offset:16384
    s_waitcnt  lgkmcnt(1)
    v_mfma_f32_32x32x16_bf16 v[112:127], v[24:27], v[92:95], v[112:127]
    ds_read_b128 v[88:91], v13 offset:16384
    s_waitcnt  lgkmcnt(1)
    v_mfma_f32_32x32x16_bf16 v[112:127], v[28:31], v[84:87], v[112:127]
    ds_read_b128 v[92:95], v14 offset:16384
    s_waitcnt  lgkmcnt(1)
    v_mfma_f32_32x32x16_bf16 v[112:127], v[32:35], v[88:91], v[112:127]
    ds_read_b128 v[84:87], v15 offset:16384
    v_mul_f32 v96, s46, v96
    v_mul_f32 v97, s46, v97
    v_mul_f32 v98, s46, v98
    v_mul_f32 v99, s46, v99
    s_waitcnt  lgkmcnt(1)
    v_mfma_f32_32x32x16_bf16 v[112:127], v[36:39], v[92:95], v[112:127]
    ds_read_b128 v[88:91], v16 offset:16384
    v_cvt_pk_bf16_f32 v96, v96, v97
    v_cvt_pk_bf16_f32 v97, v98, v99
    ds_write_b64 v3, v[96:97] offset:0
    v_mul_f32 v100, s46, v100
    s_waitcnt  lgkmcnt(2)
    v_mfma_f32_32x32x16_bf16 v[112:127], v[40:43], v[84:87], v[112:127]
    ds_read_b128 v[92:95], v17 offset:16384
    v_mul_f32 v101, s46, v101
    v_mul_f32 v102, s46, v102
    v_mul_f32 v103, s46, v103
    v_cvt_pk_bf16_f32 v100, v100, v101
    s_waitcnt  lgkmcnt(2)
    v_mfma_f32_32x32x16_bf16 v[112:127], v[44:47], v[88:91], v[112:127]
    ds_read_b128 v[84:87], v10 offset:16640
    v_cvt_pk_bf16_f32 v101, v102, v103
    ds_write_b64 v3, v[100:101] offset:16
    v_mul_f32 v104, s46, v104
    v_mul_f32 v105, s46, v105
    s_waitcnt  lgkmcnt(2)
    v_mfma_f32_32x32x16_bf16 v[112:127], v[48:51], v[92:95], v[112:127]
    ds_read_b128 v[88:91], v11 offset:16640
    v_mul_f32 v106, s46, v106
    v_mul_f32 v107, s46, v107
    v_cvt_pk_bf16_f32 v104, v104, v105
    v_cvt_pk_bf16_f32 v105, v106, v107
    s_waitcnt  lgkmcnt(2)
    v_mfma_f32_32x32x16_bf16 v[112:127], v[52:55], v[84:87], v[112:127]
    ds_read_b128 v[92:95], v12 offset:16640
    ds_write_b64 v3, v[104:105] offset:32
    v_mul_f32 v108, s46, v108
    v_mul_f32 v109, s46, v109
    v_mul_f32 v110, s46, v110
    s_waitcnt  lgkmcnt(2)
    v_mfma_f32_32x32x16_bf16 v[112:127], v[56:59], v[88:91], v[112:127]
    ds_read_b128 v[84:87], v13 offset:16640
    v_mul_f32 v111, s46, v111
    v_cvt_pk_bf16_f32 v108, v108, v109
    v_cvt_pk_bf16_f32 v109, v110, v111
    ds_write_b64 v3, v[108:109] offset:48
    s_waitcnt  lgkmcnt(3)
    v_mfma_f32_32x32x16_bf16 v[112:127], v[60:63], v[92:95], v[112:127]
    ds_read_b128 v[88:91], v14 offset:16640
    s_waitcnt  lgkmcnt(2)
    v_mfma_f32_32x32x16_bf16 v[112:127], v[64:67], v[84:87], v[112:127]
    ds_read_b128 v[92:95], v15 offset:16640
    s_waitcnt vmcnt(0) lgkmcnt(2)
    s_barrier
    s_waitcnt  lgkmcnt(1)
    v_mfma_f32_32x32x16_bf16 v[112:127], v[68:71], v[88:91], v[112:127]
    ds_read_b128 v[84:87], v16 offset:16640
    s_waitcnt  lgkmcnt(1)
    v_mfma_f32_32x32x16_bf16 v[112:127], v[72:75], v[92:95], v[112:127]
    ds_read_b128 v[88:91], v17 offset:16640
    s_waitcnt  lgkmcnt(1)
    v_mfma_f32_32x32x16_bf16 v[112:127], v[76:79], v[84:87], v[112:127]
    ds_read_b128 v[92:95], v10 offset:32768
    s_waitcnt  lgkmcnt(1)
    v_mfma_f32_32x32x16_bf16 v[112:127], v[80:83], v[88:91], v[112:127]
    ds_read_b128 v[84:87], v11 offset:32768
    s_waitcnt  lgkmcnt(1)
    v_mfma_f32_32x32x16_bf16 v[96:111], v[20:23], v[92:95], 0
    ds_read_b128 v[88:91], v12 offset:32768
    s_waitcnt  lgkmcnt(1)
    v_mfma_f32_32x32x16_bf16 v[96:111], v[24:27], v[84:87], v[96:111]
    ds_read_b128 v[92:95], v13 offset:32768
    s_waitcnt  lgkmcnt(1)
    v_mfma_f32_32x32x16_bf16 v[96:111], v[28:31], v[88:91], v[96:111]
    ds_read_b128 v[84:87], v14 offset:32768
    s_waitcnt  lgkmcnt(1)
    v_mfma_f32_32x32x16_bf16 v[96:111], v[32:35], v[92:95], v[96:111]
    ds_read_b128 v[88:91], v15 offset:32768
    v_mul_f32 v112, s46, v112
    v_mul_f32 v113, s46, v113
    v_mul_f32 v114, s46, v114
    v_mul_f32 v115, s46, v115
    s_waitcnt  lgkmcnt(1)
    v_mfma_f32_32x32x16_bf16 v[96:111], v[36:39], v[84:87], v[96:111]
    ds_read_b128 v[92:95], v16 offset:32768
    v_cvt_pk_bf16_f32 v112, v112, v113
    v_cvt_pk_bf16_f32 v113, v114, v115
    ds_write_b64 v3, v[112:113] offset:8704
    v_mul_f32 v116, s46, v116
    s_waitcnt  lgkmcnt(2)
    v_mfma_f32_32x32x16_bf16 v[96:111], v[40:43], v[88:91], v[96:111]
    ds_read_b128 v[84:87], v17 offset:32768
    v_mul_f32 v117, s46, v117
    v_mul_f32 v118, s46, v118
    v_mul_f32 v119, s46, v119
    v_cvt_pk_bf16_f32 v116, v116, v117
    s_waitcnt  lgkmcnt(2)
    v_mfma_f32_32x32x16_bf16 v[96:111], v[44:47], v[92:95], v[96:111]
    ds_read_b128 v[88:91], v10 offset:33024
    v_cvt_pk_bf16_f32 v117, v118, v119
    ds_write_b64 v3, v[116:117] offset:8720
    v_mul_f32 v120, s46, v120
    v_mul_f32 v121, s46, v121
    s_waitcnt  lgkmcnt(2)
    v_mfma_f32_32x32x16_bf16 v[96:111], v[48:51], v[84:87], v[96:111]
    ds_read_b128 v[92:95], v11 offset:33024
    v_mul_f32 v122, s46, v122
    v_mul_f32 v123, s46, v123
    v_cvt_pk_bf16_f32 v120, v120, v121
    v_cvt_pk_bf16_f32 v121, v122, v123
    s_waitcnt  lgkmcnt(2)
    v_mfma_f32_32x32x16_bf16 v[96:111], v[52:55], v[88:91], v[96:111]
    ds_read_b128 v[84:87], v12 offset:33024
    ds_write_b64 v3, v[120:121] offset:8736
    v_mul_f32 v124, s46, v124
    v_mul_f32 v125, s46, v125
    v_mul_f32 v126, s46, v126
    s_waitcnt  lgkmcnt(2)
    v_mfma_f32_32x32x16_bf16 v[96:111], v[56:59], v[92:95], v[96:111]
    ds_read_b128 v[88:91], v13 offset:33024
    v_mul_f32 v127, s46, v127
    v_cvt_pk_bf16_f32 v124, v124, v125
    v_cvt_pk_bf16_f32 v125, v126, v127
    ds_write_b64 v3, v[124:125] offset:8752
    s_waitcnt  lgkmcnt(3)
    v_mfma_f32_32x32x16_bf16 v[96:111], v[60:63], v[84:87], v[96:111]
    ds_read_b128 v[92:95], v14 offset:33024
    s_waitcnt  lgkmcnt(2)
    v_mfma_f32_32x32x16_bf16 v[96:111], v[64:67], v[88:91], v[96:111]
    ds_read_b128 v[84:87], v15 offset:33024
    s_waitcnt vmcnt(0) lgkmcnt(2)
    s_barrier
    s_waitcnt  lgkmcnt(1)
    v_mfma_f32_32x32x16_bf16 v[96:111], v[68:71], v[92:95], v[96:111]
    ds_read_b128 v[88:91], v16 offset:33024
    s_waitcnt  lgkmcnt(1)
    v_mfma_f32_32x32x16_bf16 v[96:111], v[72:75], v[84:87], v[96:111]
    ds_read_b128 v[92:95], v17 offset:33024
    s_waitcnt  lgkmcnt(1)
    v_mfma_f32_32x32x16_bf16 v[96:111], v[76:79], v[88:91], v[96:111]
    s_waitcnt  lgkmcnt(0)
    v_mfma_f32_32x32x16_bf16 v[96:111], v[80:83], v[92:95], v[96:111]
    s_nop 7
    s_nop 3
    s_mov_b32 exec_lo, 0xffff
    s_mov_b32 exec_hi, 0xffff
    v_mul_f32 v96, s46, v96
    v_mul_f32 v97, s46, v97
    v_mul_f32 v98, s46, v98
    v_mul_f32 v99, s46, v99
    v_cvt_pk_bf16_f32 v96, v96, v97
    v_cvt_pk_bf16_f32 v97, v98, v99
    ds_write_b64 v3, v[96:97] offset:17408
    v_mul_f32 v100, s46, v100
    v_mul_f32 v101, s46, v101
    v_mul_f32 v102, s46, v102
    v_mul_f32 v103, s46, v103
    v_cvt_pk_bf16_f32 v100, v100, v101
    v_cvt_pk_bf16_f32 v101, v102, v103
    ds_write_b64 v3, v[100:101] offset:17424
    v_mul_f32 v104, s46, v104
    v_mul_f32 v105, s46, v105
    v_mul_f32 v106, s46, v106
    v_mul_f32 v107, s46, v107
    v_cvt_pk_bf16_f32 v104, v104, v105
    v_cvt_pk_bf16_f32 v105, v106, v107
    ds_write_b64 v3, v[104:105] offset:17440
    v_mul_f32 v108, s46, v108
    v_mul_f32 v109, s46, v109
    v_mul_f32 v110, s46, v110
    v_mul_f32 v111, s46, v111
    v_cvt_pk_bf16_f32 v108, v108, v109
    v_cvt_pk_bf16_f32 v109, v110, v111
    ds_write_b64 v3, v[108:109] offset:17456
    s_waitcnt lgkmcnt(0)
    s_barrier
    s_mov_b64 exec, -1
    s_branch K1_done
K1_idle:
    s_waitcnt lgkmcnt(0)
    s_barrier
    s_barrier
    s_barrier
    s_barrier
    s_barrier
    s_barrier
    s_branch K1_done
.globl gather_scatter__cheap_equivariant_egnn__graph_kernel
.p2align 8
.type gather_scatter__cheap_equivariant_egnn__graph_kernel,@function
gather_scatter__cheap_equivariant_egnn__graph_kernel:
    s_and_b32 s38, s2, 7
    s_lshr_b32 s39, s2, 3
    s_lshl_b32 s38, s38, 5
    s_add_u32 s36, s38, s39
    s_cmp_ge_u32 s2, 256
    s_cbranch_scc1 K2_exit
    s_cmp_ge_u32 s36, 250
    s_cbranch_scc1 K2_exit
    s_load_dwordx2 s[24:25], s[0:1], 80
    s_load_dwordx2 s[28:29], s[0:1], 0
    s_load_dwordx2 s[22:23], s[0:1], 48
    s_load_dwordx2 s[20:21], s[0:1], 64
    s_load_dwordx2 s[66:67], s[0:1], 8
    s_setprio 3
    v_lshrrev_b32 v80, 6, v0
    v_and_b32 v1, 63, v0
    v_readfirstlane_b32 s37, v80
    s_mov_b32 s26, 51060736
    s_mov_b32 s27, 0x20000
    s_mov_b32 s30, 5120000
    s_mov_b32 s31, 0x20000
    s_lshl_b32 s38, s37, 15
    s_lshl_b32 s39, s36, 2
    s_add_u32 s38, s38, s39
    s_add_u32 s38, s38, 8454144
    v_lshl_add_u32 v84, v1, 10, s38
    v_mov_b32 v17, 0
    v_mov_b64 v[64:65], 0
    v_mov_b64 v[66:67], 0
    v_lshlrev_b32 v68, 4, v0
    v_add_u32 v69, 44800, v68
    v_add_u32 v70, 110336, v68
    v_lshlrev_b32 v71, 3, v0
    ds_write_b64 v71, v[64:65] offset:23680
    s_cmp_lg_u32 s37, 0
    s_cbranch_scc1 K2_nolow_1
    ds_write_b128 v68, v[64:67]
K2_nolow_1:
    ds_write_b128 v69, v[64:67] offset:0
    ds_write_b128 v69, v[64:67] offset:8192
    s_mul_i32 s39, s36, 20480
    s_lshl_b32 s40, s37, 6
    s_waitcnt lgkmcnt(0)
    s_mov_b32 exec_hi, 0
    buffer_load_dword v17, v84, s[24:27], 0 offen
    s_mov_b32 exec_hi, -1
    s_add_u32 s22, s22, s40
    s_addc_u32 s23, s23, 0
    s_load_dwordx16 s[4:19], s[22:23], 0
    s_add_u32 s38, s39, 8192
    s_add_u32 s40, s39, 16384
    s_mov_b32 s54, 9109504
    buffer_load_dwordx2 v[142:143], v71, s[24:27], s54 offen
    buffer_load_dwordx4 v[32:35], v68, s[28:31], s39 offen
    buffer_load_dwordx4 v[36:39], v68, s[28:31], s38 offen
    buffer_load_dwordx4 v[40:43], v68, s[28:31], s40 offen
    s_mul_i32 s38, s36, 240
    v_min_u32 v80, 119, v0
    v_lshl_add_u32 v80, v80, 1, s38
    global_load_ushort v44, v80, s[66:67]
    s_mov_b32 s46, 0
    s_mov_b32 s47, 128
    s_mov_b32 s48, 1
    s_mov_b32 s51, 1
    s_mov_b32 s52, 0
    s_lshl_b32 s38, s37, 5
    v_add_u32 v84, s38, v1
    v_mul_u32_u24 v84, 12544, v84
    v_add_u32 v87, 5242880, v84
    s_lshl_b32 s38, s37, 9
    s_add_u32 s38, s38, 23680
    v_mov_b32 v18, s38
    v_lshlrev_b32 v11, 4, v1
    s_lshl_b32 s56, s37, 14
    s_add_u32 s56, s56, 8716288
    s_mov_b32 s62, 0x11111111
    s_mov_b32 s63, 0x11111111
    s_mov_b32 s64, 0xbfb8aa3b
    s_lshl_b32 s55, s37, 12
    s_add_u32 s55, s55, 127744
    s_mov_b32 m0, s55
    s_add_u32 s32, s24, 1024
    s_addc_u32 s33, s25, 0
    s_or_b32 s33, s33, 0x2000000
    s_mov_b32 s34, 10000
    s_mov_b32 s35, 0x20000
    s_lshl_b32 s40, s37, 6
    v_lshrrev_b32 v83, 4, v1
    v_xor_b32 v80, v83, v1
    v_and_b32 v80, 3, v80
    v_lshl_add_u32 v31, v80, 4, s40
    v_add_u32 v29, 1024, v31
    v_add_u32 v27, 2048, v31
    v_add_u32 v25, 3072, v31
    v_and_b32 v80, 31, v1
    v_lshrrev_b32 v81, 5, v1
    v_bfe_u32 v82, v1, 2, 2
    v_xor_b32 v82, v82, v81
    v_lshl_add_u32 v82, v82, 4, s55
    v_lshl_add_u32 v4, v80, 6, v82
    v_xor_b32 v5, 32, v4
    s_add_u32 s38, s40, 2048
    v_lshl_add_u32 v84, v81, 3, s38
    v_lshrrev_b32 v82, 2, v80
    v_mul_u32_u24 v82, 528, v82
    v_add_u32 v82, v82, v84
    v_add_u32 v6, 21632, v82
    v_mul_u32_u24 v80, 528, v80
    v_add_u32 v9, v80, v84
    v_lshlrev_b32 v81, 4, v81
    v_add_u32 v81, 2048, v81
    v_add_u32 v7, v80, v81
    v_lshrrev_b32 v80, 1, v1
    v_and_b32 v80, 4, v80
    v_and_or_b32 v80, v1, 3, v80
    v_mul_u32_u24 v80, 528, v80
    v_add_u32 v80, 16896, v80
    v_add_u32 v8, v80, v81
    v_lshl_add_u32 v80, v83, 3, v80
    v_and_b32 v82, 4, v1
    v_lshl_add_u32 v80, v82, 3, v80
    v_add_u32 v10, s38, v80
    v_and_b32 v80, 3, v1
    v_lshlrev_b32 v80, 4, v80
    v_mov_b32 v82, 0x3f80
    v_mov_b32 v83, 0
    v_lshlrev_b64 v[82:83], v80, v[82:83]
    v_mov_b64 v[152:153], 0
    v_mov_b64 v[154:155], 0
    v_mov_b64 v[156:157], 0
    v_mov_b64 v[158:159], 0
    s_mov_b32 exec_lo, 0xf
    s_mov_b32 exec_hi, 0xf00
    v_mov_b64 v[152:153], v[82:83]
    s_mov_b32 exec_lo, 0xf0
    s_mov_b32 exec_hi, 0xf000
    v_mov_b64 v[154:155], v[82:83]
    s_mov_b32 exec_lo, 0xf0000
    s_mov_b32 exec_hi, 0xf000000
    v_mov_b64 v[156:157], v[82:83]
    s_mov_b32 exec_lo, 0xf00000
    s_mov_b32 exec_hi, 0xf0000000
    v_mov_b64 v[158:159], v[82:83]
    s_mov_b32 exec_lo, 0xf0ff0f0
    s_mov_b32 exec_hi, 0xf0ff0f0
    v_mov_b32 v8, 64
    s_mov_b64 exec, -1
    s_waitcnt vmcnt(5)
    v_and_b32 v80, 0xffff, v17
    v_lshrrev_b32 v17, 16, v17
    v_mov_b32 v16, v17
    s_nop 1
    v_add_u32_dpp v17, v17, v17 row_shr:1 row_mask:0xf bank_mask:0xf bound_ctrl:1
    s_nop 1
    v_add_u32_dpp v17, v17, v17 row_shr:2 row_mask:0xf bank_mask:0xf bound_ctrl:1
    s_nop 1
    v_add_u32_dpp v17, v17, v17 row_shr:4 row_mask:0xf bank_mask:0xf bound_ctrl:1
    s_nop 1
    v_add_u32_dpp v17, v17, v17 row_shr:8 row_mask:0xf bank_mask:0xf bound_ctrl:1
    s_nop 1
    v_add_u32_dpp v17, v17, v17 row_bcast:15 row_mask:0xa bank_mask:0xf
    v_sub_u32 v16, v17, v16
    v_readlane_b32 s49, v17, 31
    v_sub_u32 v80, v80, v16
    v_mad_i32_i24 v15, v80, 20, v87
K2_expand:
    s_add_u32 s38, s46, s47
    v_cmp_lt_u32 vcc, v16, v17
    v_cmp_lt_u32 s[58:59], s46, v17
    v_cmp_gt_u32 s[60:61], s38, v16
    v_subrev_u32 v80, s46, v16
    v_max_i32 v80, 0, v80
    v_lshl_add_u32 v80, v80, 2, v18
    v_lshl_add_u32 v81, v1, 2, v18
    s_and_b64 vcc, vcc, s[58:59]
    s_and_b64 exec, vcc, s[60:61]
    ds_write_b32 v80, v15
    s_mov_b64 exec, -1
    ds_read2st64_b32 v[82:83], v81 offset0:0 offset1:1
    s_sub_i32 s39, s49, s46
    s_max_i32 s39, s39, 0
    s_min_u32 s39, s39, s47
    v_add_u32 v84, 64, v1
    v_cmp_gt_u32 s[58:59], s39, v1
    v_cmp_gt_u32 s[60:61], s39, v84
    v_add_u32 v84, s46, v1
    v_mul_u32_u24 v84, 20, v84
    v_mov_b32 v85, 0x7fffff00
    s_waitcnt lgkmcnt(0)
    s_nop 0
    v_max_u32_dpp v82, v82, v82 row_shr:1 row_mask:0xf bank_mask:0xf bound_ctrl:1
    v_max_u32_dpp v83, v83, v83 row_shr:1 row_mask:0xf bank_mask:0xf bound_ctrl:1
    s_nop 0
    v_max_u32_dpp v82, v82, v82 row_shr:2 row_mask:0xf bank_mask:0xf bound_ctrl:1
    v_max_u32_dpp v83, v83, v83 row_shr:2 row_mask:0xf bank_mask:0xf bound_ctrl:1
    s_nop 0
    v_max_u32_dpp v82, v82, v82 row_shr:4 row_mask:0xf bank_mask:0xf bound_ctrl:1
    v_max_u32_dpp v83, v83, v83 row_shr:4 row_mask:0xf bank_mask:0xf bound_ctrl:1
    s_nop 0
    v_max_u32_dpp v82, v82, v82 row_shr:8 row_mask:0xf bank_mask:0xf bound_ctrl:1
    v_max_u32_dpp v83, v83, v83 row_shr:8 row_mask:0xf bank_mask:0xf bound_ctrl:1
    s_nop 0
    v_max_u32_dpp v82, v82, v82 row_bcast:15 row_mask:0xa bank_mask:0xf
    v_max_u32_dpp v83, v83, v83 row_bcast:15 row_mask:0xa bank_mask:0xf
    s_nop 0
    v_max_u32_dpp v82, v82, v82 row_bcast:31 row_mask:0xc bank_mask:0xf
    v_max_u32_dpp v83, v83, v83 row_bcast:31 row_mask:0xc bank_mask:0xf
    s_nop 0
    v_readlane_b32 s38, v82, 63
    v_add_u32 v82, v82, v84
    v_add_u32 v84, 1280, v84
    v_max_u32 v83, s38, v83
    v_add_u32 v83, v83, v84
    v_cndmask_b32_e64 v82, v85, v82, s[58:59]
    v_cndmask_b32_e64 v83, v85, v83, s[60:61]
    buffer_load_dwordx4 v[48:51], v82, s[24:27], 0 offen
    buffer_load_dwordx4 v[56:59], v83, s[24:27], 0 offen
    buffer_load_dword v52, v82, s[24:27], 0 offen offset:16
    buffer_load_dword v60, v83, s[24:27], 0 offen offset:16
    s_cmp_eq_u32 s51, 0
    s_cbranch_scc1 K2_again1
    s_setprio 0
    ds_write_b128 v69, v[64:67] offset:16384
    ds_write_b128 v69, v[64:67] offset:24576
    ds_write_b128 v69, v[64:67] offset:32768
    ds_write_b128 v69, v[64:67] offset:40960
    ds_write_b128 v69, v[64:67] offset:49152
    ds_write_b128 v69, v[64:67] offset:57344
    ds_write_b128 v70, v[64:67] offset:0
    ds_write_b128 v70, v[64:67] offset:8192
    ds_write_b128 v70, v[64:67] offset:16384
    s_cmp_lg_u32 s37, 7
    s_cbranch_scc1 K2_nopad
    v_min_u32 v80, 39, v1
    v_sub_u32 v81, v1, v80
    v_mul_u32_u24 v80, 528, v80
    v_lshl_add_u32 v80, v81, 4, v80
    ds_write_b128 v80, v[64:67] offset:2560
K2_nopad:
    v_lshrrev_b32 v80, 5, v0
    v_and_b32 v81, 31, v0
    v_mul_u32_u24 v80, 528, v80
    v_lshl_add_u32 v80, v81, 4, v80
    s_waitcnt vmcnt(4)
    ds_write_b128 v80, v[32:35] offset:2048
    ds_write_b128 v80, v[36:39] offset:10496
    s_cmp_ge_u32 s37, 4
    s_cbranch_scc1 K2_h2
    ds_write_b128 v80, v[40:43] offset:18944
    s_cmp_ge_u32 s37, 2
    s_cbranch_scc1 K2_h2
    v_min_u32 v80, 119, v0
    v_mul_u32_u24 v81, 171, v80
    v_lshrrev_b32 v81, 9, v81
    v_add_lshl_u32 v80, v80, v81, 2
    v_lshlrev_b32 v81, 16, v44
    ds_write_b32 v80, v81 offset:1024
K2_h2:
    v_mov_b32 v160, s4
    v_mov_b32 v161, s5
    v_mov_b32 v162, s8
    v_mov_b32 v163, s9
    v_mov_b32 v164, s12
    v_mov_b32 v165, s13
    v_mov_b32 v166, s16
    v_mov_b32 v167, s17
    s_mov_b32 exec_lo, 0
    v_mov_b32 v160, s6
    v_mov_b32 v161, s7
    v_mov_b32 v162, s10
    v_mov_b32 v163, s11
    v_mov_b32 v164, s14
    v_mov_b32 v165, s15
    v_mov_b32 v166, s18
    v_mov_b32 v167, s19
    s_mov_b32 exec_lo, -1
    s_add_u32 s28, s24, s56
    s_addc_u32 s29, s25, 0
    s_add_u32 s28, s28, 131072
    s_addc_u32 s29, s29, 0
K2_back1:
    v_mov_b32 v95, 0x3f80
    v_mov_b32 v86, 1
    v_mov_b32 v87, s49
    v_mov_b32 v85, 24
    v_min_u32 v84, 7, v1
    v_lshlrev_b32 v84, 2, v84
    s_waitcnt lgkmcnt(0)
    s_barrier
    s_mov_b64 exec, 1
    ds_max_u32 v85, v87
    s_mov_b64 exec, -1
    s_cmp_lg_u32 s52, 0
    s_cbranch_scc1 K2_w1d_2
    s_add_u32 s54, s56, 0
    buffer_load_dwordx4 v[188:191], v11, s[24:27], s54 offen offset:0
    buffer_load_dwordx4 v[192:195], v11, s[24:27], s54 offen offset:1024
    buffer_load_dwordx4 v[196:199], v11, s[24:27], s54 offen offset:2048
    buffer_load_dwordx4 v[200:203], v11, s[24:27], s54 offen offset:3072
    s_waitcnt vmcnt(6)
K2_w1d_2:
    v_lshrrev_b32 v54, 1, v51
    v_and_b32 v54, 0x1c, v54
    v_and_b32 v80, 63, v51
    s_mov_b64 exec, s[58:59]
    ds_add_rtn_u32 v55, v54, v86 offset:0
    s_mov_b64 exec, -1
    v_lshlrev_b32 v80, 4, v80
    ds_read_b128 v[64:67], v80 offset:1024
    v_lshrrev_b32 v62, 1, v59
    v_and_b32 v62, 0x1c, v62
    v_and_b32 v80, 63, v59
    s_mov_b64 exec, s[60:61]
    ds_add_rtn_u32 v63, v62, v86 offset:0
    s_mov_b64 exec, -1
    v_lshlrev_b32 v80, 4, v80
    ds_read_b128 v[68:71], v80 offset:1024
    v_lshlrev_b32 v86, 1, v1
    v_add_u32 v86, 8, v86
    v_cmp_gt_u32 vcc, 5, v1
    s_waitcnt lgkmcnt(0)
    s_barrier
    ds_read_b32 v80, v84 offset:0
    s_cmp_lg_u32 s52, 0
    s_cbranch_scc1 K2_w1d_3
    s_add_u32 s54, s56, 4096
    buffer_load_dwordx4 v[204:207], v11, s[24:27], s54 offen offset:0
    buffer_load_dwordx4 v[208:211], v11, s[24:27], s54 offen offset:1024
    buffer_load_dwordx4 v[212:215], v11, s[24:27], s54 offen offset:2048
    buffer_load_dwordx4 v[216:219], v11, s[24:27], s54 offen offset:3072
    s_waitcnt vmcnt(8)
K2_w1d_3:
    s_waitcnt lgkmcnt(0)
    v_readlane_b32 s39, v80, 6
    v_max_u32 v81, 1, v80
    v_add_u32 v82, -1, v81
    v_lshrrev_b32 v81, 5, v82
    v_add_u32 v81, 1, v81
    v_bfe_u32 v82, v82, 3, 2
    v_lshl_or_b32 v82, v82, v86, v81
    v_cndmask_b32_e64 v82, 0, v82, vcc
    v_lshlrev_b32 v72, 16, v50
    v_and_b32 v73, 0xffff0000, v50
    v_add_u32_dpp v82, v82, v82 row_shr:1 row_mask:0xf bank_mask:0xf bound_ctrl:1
    v_lshlrev_b32 v74, 16, v52
    v_sub_f32 v72, v64, v72
    v_add_u32_dpp v82, v82, v82 row_shr:2 row_mask:0xf bank_mask:0xf bound_ctrl:1
    v_sub_f32 v73, v65, v73
    v_sub_f32 v74, v66, v74
    v_add_u32_dpp v82, v82, v82 row_shr:4 row_mask:0xf bank_mask:0xf bound_ctrl:1
    v_cvt_pk_bf16_f32 v52, 1.0, v72
    v_readlane_b32 s43, v82, 4
    v_and_b32 v82, 0xff, v82
    v_sub_u32 v83, v82, v81
    v_mul_u32_u24 v83, 3072, v83
    v_add_u32 v83, 44800, v83
    ds_bpermute_b32 v54, v54, v83
    ds_bpermute_b32 v62, v62, v83
    v_sub_u32 v82, 32, v82
    v_lshlrev_b32 v82, v82, 1
    v_cndmask_b32_e64 v82, 0, v82, vcc
    s_and_b32 s38, s43, 0xff
    s_lshr_b32 s43, s43, 8
    v_add_u32_dpp v82, v82, v82 row_shr:1 row_mask:0xf bank_mask:0xf bound_ctrl:1
    v_cvt_pk_bf16_f32 v53, v73, v74
    v_and_b32 v72, 0xffff0000, v52
    v_add_u32_dpp v82, v82, v82 row_shr:2 row_mask:0xf bank_mask:0xf bound_ctrl:1
    v_lshlrev_b32 v73, 16, v53
    v_and_b32 v74, 0xffff0000, v53
    v_add_u32_dpp v82, v82, v82 row_shr:4 row_mask:0xf bank_mask:0xf bound_ctrl:1
    v_mul_f32 v72, v72, v72
    v_mul_f32 v73, v73, v73
    v_readlane_b32 s42, v82, 4
    s_cmp_gt_u32 s38, 27
    s_cselect_b32 s53, 1, 0
    s_cmp_eq_u32 s51, 0
    s_cbranch_scc1 K2_notfirst
    s_mov_b32 s50, s39
    s_cmp_gt_u32 s39, 128
    s_cselect_b32 s53, 1, s53
K2_notfirst:
    s_mov_b32 s51, 0
    s_cmp_lg_u32 s52, 0
    s_cbranch_scc1 K2_w1d_4
    s_add_u32 s54, s56, 8192
    buffer_load_dwordx4 v[220:223], v11, s[24:27], s54 offen offset:0
    buffer_load_dwordx4 v[224:227], v11, s[24:27], s54 offen offset:1024
    buffer_load_dwordx4 v[228:231], v11, s[24:27], s54 offen offset:2048
    buffer_load_dwordx4 v[232:235], v11, s[24:27], s54 offen offset:3072
K2_w1d_4:
    s_cmp_lg_u32 s53, 0
    s_cbranch_scc1 K2_over1
    v_mul_f32 v74, v74, v74
    v_cvt_pk_bf16_f32 v72, v72, v73
    v_cvt_pk_bf16_f32 v74, v74, v74
    v_lshlrev_b32 v73, 16, v72
    v_and_b32 v72, 0xffff0000, v72
    v_lshlrev_b32 v74, 16, v74
    v_add_f32 v73, v73, v72
    v_add_f32 v73, v73, v74
    v_cvt_pk_bf16_f32 v50, v73, 0
    v_lshrrev_b32 v72, 5, v55
    v_mul_u32_u24 v72, 3072, v72
    v_and_b32 v73, 31, v55
    v_lshl_add_u32 v32, v73, 4, v72
    v_lshl_add_u32 v33, v73, 6, v72
    v_and_b32 v73, 7, v51
    v_lshl_add_u32 v33, v73, 3, v33
    v_and_b32 v73, 4, v51
    v_lshl_add_u32 v34, v73, 7, v32
    v_and_b32 v73, 3, v51
    v_lshl_add_u32 v34, v73, 1, v34
    s_waitcnt lgkmcnt(0)
    v_add_u32 v32, v32, v54
    v_add_u32 v33, v33, v54
    v_add_u32 v34, v34, v54
    s_mov_b64 exec, s[58:59]
    ds_write_b64 v32, v[50:51] offset:520
    ds_write_b64 v32, v[48:49] offset:8
    ds_write_b64 v33, v[52:53] offset:1024
    ds_write_b16 v34, v95
    s_mov_b64 exec, -1
    v_lshlrev_b32 v72, 16, v58
    v_and_b32 v73, 0xffff0000, v58
    v_lshlrev_b32 v74, 16, v60
    v_sub_f32 v72, v68, v72
    v_sub_f32 v73, v69, v73
    v_sub_f32 v74, v70, v74
    v_cvt_pk_bf16_f32 v60, 1.0, v72
    v_cvt_pk_bf16_f32 v61, v73, v74
    v_and_b32 v72, 0xffff0000, v60
    v_lshlrev_b32 v73, 16, v61
    v_and_b32 v74, 0xffff0000, v61
    v_mul_f32 v72, v72, v72
    v_mul_f32 v73, v73, v73
    v_mul_f32 v74, v74, v74
    v_cvt_pk_bf16_f32 v72, v72, v73
    v_cvt_pk_bf16_f32 v74, v74, v74
    v_lshlrev_b32 v73, 16, v72
    v_and_b32 v72, 0xffff0000, v72
    v_lshlrev_b32 v74, 16, v74
    v_add_f32 v73, v73, v72
    v_add_f32 v73, v73, v74
    v_cvt_pk_bf16_f32 v58, v73, 0
    v_lshrrev_b32 v72, 5, v63
    v_mul_u32_u24 v72, 3072, v72
    v_and_b32 v73, 31, v63
    v_lshl_add_u32 v36, v73, 4, v72
    v_lshl_add_u32 v37, v73, 6, v72
    v_and_b32 v73, 7, v59
    v_lshl_add_u32 v37, v73, 3, v37
    v_and_b32 v73, 4, v59
    v_lshl_add_u32 v38, v73, 7, v36
    v_and_b32 v73, 3, v59
    v_lshl_add_u32 v38, v73, 1, v38
    v_add_u32 v36, v36, v62
    v_add_u32 v37, v37, v62
    v_add_u32 v38, v38, v62
    s_mov_b64 exec, s[60:61]
    ds_write_b64 v36, v[58:59] offset:520
    ds_write_b64 v36, v[56:57] offset:8
    ds_write_b64 v37, v[60:61] offset:1024
    ds_write_b16 v38, v95
    s_mov_b64 exec, -1
    v_add_u32 v2, 44800, v11
    v_lshrrev_b32 v80, 2, v1
    v_lshlrev_b32 v81, 4, v80
    v_add_u32 v3, 45326, v81
    v_and_b32 v81, 3, v80
    v_lshlrev_b32 v81, 6, v81
    v_and_b32 v82, 4, v80
    v_lshl_add_u32 v81, v82, 3, v81
    v_and_b32 v82, 8, v80
    v_lshl_add_u32 v81, v82, 5, v81
    v_and_b32 v82, 3, v1
    v_lshl_add_u32 v81, v82, 3, v81
    v_add_u32 v14, 45824, v81
    s_cmp_lg_u32 s52, 0
    s_cbranch_scc1 K2_w1d_5
    s_add_u32 s54, s56, 12288
    buffer_load_dwordx4 v[236:239], v11, s[24:27], s54 offen offset:0
    buffer_load_dwordx4 v[240:243], v11, s[24:27], s54 offen offset:1024
    buffer_load_dwordx4 v[244:247], v11, s[24:27], s54 offen offset:2048
    buffer_load_dwordx4 v[248:251], v11, s[24:27], s54 offen offset:3072
K2_w1d_5:
    s_waitcnt lgkmcnt(0)
    s_barrier
    ds_read_u16 v24, v3 offset:0
    ds_read_u16 v26, v3 offset:256
    ds_read_u16 v28, v3 offset:3072
    ds_read_u16 v30, v3 offset:3328
    s_waitcnt lgkmcnt(2)
    buffer_load_dwordx4 v[24:25], s[32:35], 0 idxen offen offset:0  lds
    buffer_load_dwordx4 v[26:27], s[32:35], 0 idxen offen offset:1024  lds
    s_waitcnt lgkmcnt(0)
    buffer_load_dwordx4 v[28:29], s[32:35], 0 idxen offen offset:2048  lds
    buffer_load_dwordx4 v[30:31], s[32:35], 0 idxen offen offset:3072  lds
K2_back2:
    s_cmp_lg_u32 s52, 0
    s_cbranch_scc1 K2_adone
K2_w1d_6:
    ds_read_b128 v[64:67], v7 offset:0
    ds_read_b128 v[68:71], v8 offset:0
    ds_read_b128 v[72:75], v7 offset:32
    ds_read_b128 v[76:79], v8 offset:32
    ds_read_b128 v[80:83], v7 offset:64
    ds_read_b128 v[84:87], v8 offset:64
    s_waitcnt vmcnt(19) lgkmcnt(4)
    v_mfma_f32_32x32x16_bf16 v[32:47], v[64:67], v[188:191], 0
    ds_read_b128 v[88:91], v7 offset:96
    ds_read_b128 v[92:95], v8 offset:96
    s_waitcnt vmcnt(18) lgkmcnt(4)
    v_mfma_f32_16x16x32_bf16 v[104:107], v[68:71], v[188:191], 0
    v_mfma_f32_32x32x16_bf16 v[32:47], v[72:75], v[192:195], v[32:47]
    ds_read_b128 v[64:67], v7 offset:128
    ds_read_b128 v[68:71], v8 offset:128
    s_waitcnt vmcnt(17) lgkmcnt(4)
    v_mfma_f32_16x16x32_bf16 v[104:107], v[76:79], v[192:195], v[104:107]
    v_mfma_f32_32x32x16_bf16 v[32:47], v[80:83], v[196:199], v[32:47]
    ds_read_b128 v[72:75], v7 offset:160
    ds_read_b128 v[76:79], v8 offset:160
    s_waitcnt vmcnt(16) lgkmcnt(4)
    v_mfma_f32_16x16x32_bf16 v[104:107], v[84:87], v[196:199], v[104:107]
    v_mfma_f32_32x32x16_bf16 v[32:47], v[88:91], v[200:203], v[32:47]
    ds_read_b128 v[80:83], v7 offset:192
    ds_read_b128 v[84:87], v8 offset:192
    s_waitcnt vmcnt(15) lgkmcnt(4)
    v_mfma_f32_16x16x32_bf16 v[104:107], v[92:95], v[200:203], v[104:107]
    v_mfma_f32_32x32x16_bf16 v[32:47], v[64:67], v[204:207], v[32:47]
    ds_read_b128 v[88:91], v7 offset:224
    ds_read_b128 v[92:95], v8 offset:224
    s_waitcnt vmcnt(14) lgkmcnt(4)
    v_mfma_f32_16x16x32_bf16 v[104:107], v[68:71], v[204:207], v[104:107]
    v_mfma_f32_32x32x16_bf16 v[32:47], v[72:75], v[208:211], v[32:47]
    ds_read_b128 v[64:67], v7 offset:256
    ds_read_b128 v[68:71], v8 offset:256
    s_waitcnt vmcnt(13) lgkmcnt(4)
    v_mfma_f32_16x16x32_bf16 v[104:107], v[76:79], v[208:211], v[104:107]
    v_mfma_f32_32x32x16_bf16 v[32:47], v[80:83], v[212:215], v[32:47]
    ds_read_b128 v[72:75], v7 offset:288
    ds_read_b128 v[76:79], v8 offset:288
    s_waitcnt vmcnt(12) lgkmcnt(4)
    v_mfma_f32_16x16x32_bf16 v[104:107], v[84:87], v[212:215], v[104:107]
    v_mfma_f32_32x32x16_bf16 v[32:47], v[88:91], v[216:219], v[32:47]
    ds_read_b128 v[80:83], v7 offset:320
    ds_read_b128 v[84:87], v8 offset:320
    s_waitcnt vmcnt(11) lgkmcnt(4)
    v_mfma_f32_16x16x32_bf16 v[104:107], v[92:95], v[216:219], v[104:107]
    v_mfma_f32_32x32x16_bf16 v[32:47], v[64:67], v[220:223], v[32:47]
    ds_read_b128 v[88:91], v7 offset:352
    ds_read_b128 v[92:95], v8 offset:352
    s_waitcnt vmcnt(10) lgkmcnt(4)
    v_mfma_f32_16x16x32_bf16 v[104:107], v[68:71], v[220:223], v[104:107]
    v_mfma_f32_32x32x16_bf16 v[32:47], v[72:75], v[224:227], v[32:47]
    ds_read_b128 v[64:67], v7 offset:384
    ds_read_b128 v[68:71], v8 offset:384
    s_waitcnt vmcnt(9) lgkmcnt(4)
    v_mfma_f32_16x16x32_bf16 v[104:107], v[76:79], v[224:227], v[104:107]
    v_mfma_f32_32x32x16_bf16 v[32:47], v[80:83], v[228:231], v[32:47]
    ds_read_b128 v[72:75], v7 offset:416
    ds_read_b128 v[76:79], v8 offset:416
    s_waitcnt vmcnt(8) lgkmcnt(4)
    v_mfma_f32_16x16x32_bf16 v[104:107], v[84:87], v[228:231], v[104:107]
    v_mfma_f32_32x32x16_bf16 v[32:47], v[88:91], v[232:235], v[32:47]
    ds_read_b128 v[80:83], v7 offset:448
    ds_read_b128 v[84:87], v8 offset:448
    s_waitcnt vmcnt(7) lgkmcnt(4)
    v_mfma_f32_16x16x32_bf16 v[104:107], v[92:95], v[232:235], v[104:107]
    v_mfma_f32_32x32x16_bf16 v[32:47], v[64:67], v[236:239], v[32:47]
    ds_read_b128 v[88:91], v7 offset:480
    ds_read_b128 v[92:95], v8 offset:480
    s_waitcnt vmcnt(6) lgkmcnt(4)
    v_mfma_f32_16x16x32_bf16 v[104:107], v[68:71], v[236:239], v[104:107]
    v_mfma_f32_32x32x16_bf16 v[32:47], v[72:75], v[240:243], v[32:47]
    s_waitcnt vmcnt(5) lgkmcnt(2)
    v_mfma_f32_16x16x32_bf16 v[104:107], v[76:79], v[240:243], v[104:107]
    v_mfma_f32_32x32x16_bf16 v[32:47], v[80:83], v[244:247], v[32:47]
    s_waitcnt vmcnt(4) lgkmcnt(0)
    v_mfma_f32_16x16x32_bf16 v[104:107], v[84:87], v[244:247], v[104:107]
    v_mfma_f32_32x32x16_bf16 v[32:47], v[88:91], v[248:251], v[32:47]
    v_mfma_f32_16x16x32_bf16 v[104:107], v[92:95], v[248:251], v[104:107]
    s_mov_b32 s52, 1
    v_mov_b64 v[168:169], 0
    v_mov_b64 v[170:171], 0
    v_mov_b64 v[172:173], 0
    v_mov_b64 v[174:175], 0
    v_mov_b64 v[176:177], 0
    v_mov_b64 v[178:179], 0
    v_mov_b64 v[180:181], 0
    v_mov_b64 v[182:183], 0
    v_mov_b64 v[184:185], 0
    v_mov_b64 v[186:187], 0
    v_pk_mul_f32 v[32:33], v[32:33], s[64:65] op_sel_hi:[1,0]
    v_pk_mul_f32 v[34:35], v[34:35], s[64:65] op_sel_hi:[1,0]
    v_pk_mul_f32 v[36:37], v[36:37], s[64:65] op_sel_hi:[1,0]
    v_pk_mul_f32 v[38:39], v[38:39], s[64:65] op_sel_hi:[1,0]
    v_pk_mul_f32 v[40:41], v[40:41], s[64:65] op_sel_hi:[1,0]
    v_pk_mul_f32 v[42:43], v[42:43], s[64:65] op_sel_hi:[1,0]
    v_pk_mul_f32 v[44:45], v[44:45], s[64:65] op_sel_hi:[1,0]
    v_pk_mul_f32 v[46:47], v[46:47], s[64:65] op_sel_hi:[1,0]
    v_pk_mul_f32 v[104:105], v[104:105], s[64:65] op_sel_hi:[1,0]
    v_pk_mul_f32 v[106:107], v[106:107], s[64:65] op_sel_hi:[1,0]
    v_cvt_pk_bf16_f32 v140, v32, v33
    v_cvt_pk_bf16_f32 v141, v34, v35
    v_cvt_pk_bf16_f32 v144, v36, v37
    v_cvt_pk_bf16_f32 v145, v38, v39
    v_cvt_pk_bf16_f32 v146, v40, v41
    v_cvt_pk_bf16_f32 v147, v42, v43
    v_cvt_pk_bf16_f32 v148, v44, v45
    v_cvt_pk_bf16_f32 v149, v46, v47
    v_cvt_pk_bf16_f32 v150, v104, v105
    v_cvt_pk_bf16_f32 v151, v106, v107
K2_adone:
    s_cmp_lg_u32 s53, 0
    s_cbranch_scc1 K2_slowstart
    v_mov_b64 v[96:97], 0
    v_mov_b64 v[98:99], 0
    v_mov_b64 v[100:101], 0
    v_mov_b64 v[102:103], 0
    v_mov_b64 v[104:105], 0
    v_mov_b64 v[106:107], 0
    v_mov_b64 v[108:109], 0
    v_mov_b64 v[110:111], 0
    v_mov_b64 v[112:113], 0
    v_mov_b64 v[114:115], 0
    v_mov_b64 v[116:117], 0
    v_mov_b64 v[118:119], 0
    s_xor_b32 s44, s48, 1
    s_or_b32 s44, s44, s46
    s_min_u32 s44, s44, 1
    s_lshl_b32 s44, s44, 3
    v_mov_b32 v80, 0x3e803e80
    v_mov_b32 v81, 0x3e803e80
    v_mov_b32 v82, 0x3e803e80
    v_mov_b32 v83, 0x3e803e80
    s_mov_b32 s45, 0
    s_cmp_ge_u32 s37, 4
    s_cselect_b32 s41, 2, 99
    s_mov_b32 s57, 0
    s_lshl_b32 s30, s48, 14
    v_mov_b32 v12, v7
    v_mov_b32 v13, v8
    s_cmp_lg_u32 s46, 0
    s_cbranch_scc1 K2_reload0
K2_back3:
    s_waitcnt vmcnt(2)
    ds_read_b128 v[120:123], v4 offset:0
    ds_read_b128 v[124:127], v5 offset:0
    ds_read_u16 v24, v3 offset:6144
    ds_read_u16 v26, v3 offset:6400
    ds_read_b128 v[128:131], v2
    ds_read_b128 v[88:91], v12 offset:0
    ds_read_b128 v[92:95], v13 offset:0
    buffer_load_dwordx4 v[84:87], v11, s[28:31], s57 offen offset:0
    s_waitcnt lgkmcnt(0)
    buffer_load_dwordx4 v[24:25], s[32:35], 0 idxen offen offset:0  lds
    buffer_load_dwordx4 v[26:27], s[32:35], 0 idxen offen offset:1024  lds
    v_mfma_f32_32x32x16_bf16 v[32:47], v[128:131], v[140:143], 0
    v_mfma_f32_32x32x16_bf16 v[32:47], v[120:123], v[152:155], v[32:47]
    v_mfma_f32_32x32x16_bf16 v[32:47], v[124:127], v[156:159], v[32:47]
    s_cmp_eq_u32 s48, 0
    s_cbranch_scc1 K2_nextw
    s_setprio 1
    s_waitcnt vmcnt(2)
    s_branch K2_next
.p2align 3
K2_g0w:
    s_waitcnt vmcnt(2)
K2_g0:
    ds_read_b128 v[120:123], v4 offset:2048
    ds_read_b128 v[124:127], v5 offset:2048
    ds_read_u16 v28, v3 offset:9216
    ds_read_u16 v30, v3 offset:9472
    ds_read_b128 v[128:131], v2 offset:3072
    v_exp_f32 v64, v32
    v_mfma_f32_32x32x16_bf16 v[168:183], v[84:87], v[88:91], v[168:183]
    v_exp_f32 v65, v33
    v_exp_f32 v66, v34
    v_exp_f32 v67, v35
    v_exp_f32 v68, v36
    v_mfma_f32_16x16x32_bf16 v[184:187], v[84:87], v[92:95], v[184:187]
    v_exp_f32 v69, v37
    s_waitcnt lgkmcnt(0)
    v_mfma_f32_32x32x16_bf16 v[48:63], v[128:131], v[140:143], 0
    v_exp_f32 v70, v38
    v_exp_f32 v71, v39
    v_exp_f32 v72, v40
    v_mfma_f32_32x32x16_bf16 v[48:63], v[120:123], v[152:155], v[48:63]
    v_exp_f32 v73, v41
    v_exp_f32 v74, v42
    v_exp_f32 v75, v43
    v_mfma_f32_32x32x16_bf16 v[48:63], v[124:127], v[156:159], v[48:63]
    v_exp_f32 v76, v44
    v_exp_f32 v77, v45
    v_exp_f32 v78, v46
    v_exp_f32 v79, v47
    buffer_load_dwordx4 v[84:87], v11, s[28:31], s57 offen offset:1024
    buffer_load_dwordx4 v[28:29], s[32:35], 0 idxen offen offset:2048  lds
    v_mfma_f32_32x32x16_bf16 v[64:79], v[80:83], v[80:83], v[64:79]
    buffer_load_dwordx4 v[30:31], s[32:35], 0 idxen offen offset:3072  lds
    ds_read_b64_tr_b16 v[132:133], v14 offset:0
    ds_read_b64_tr_b16 v[134:135], v14 offset:512
    ds_read_b64_tr_b16 v[136:137], v14 offset:1024
    ds_read_b64_tr_b16 v[138:139], v14 offset:1536
    ds_read_b128 v[88:91], v12 offset:32
    ds_read_b128 v[92:95], v13 offset:32
    s_nop 4
    v_rcp_f32 v64, v64
    v_rcp_f32 v65, v65
    v_rcp_f32 v66, v66
    v_rcp_f32 v67, v67
    v_rcp_f32 v68, v68
    v_rcp_f32 v69, v69
    v_rcp_f32 v70, v70
    v_rcp_f32 v71, v71
    v_rcp_f32 v72, v72
    v_rcp_f32 v73, v73
    v_rcp_f32 v74, v74
    v_rcp_f32 v75, v75
    v_rcp_f32 v76, v76
    v_rcp_f32 v77, v77
    v_rcp_f32 v78, v78
    v_rcp_f32 v79, v79
    s_waitcnt lgkmcnt(0)
    v_pk_mul_f32 v[64:65], v[64:65], v[32:33]
    v_pk_mul_f32 v[66:67], v[66:67], v[34:35]
    v_pk_mul_f32 v[68:69], v[68:69], v[36:37]
    v_pk_mul_f32 v[70:71], v[70:71], v[38:39]
    v_cvt_pk_bf16_f32 v96, v64, v65
    v_cvt_pk_bf16_f32 v97, v66, v67
    v_cvt_pk_bf16_f32 v98, v68, v69
    v_cvt_pk_bf16_f32 v99, v70, v71
    v_pk_mul_f32 v[72:73], v[72:73], v[40:41]
    v_pk_mul_f32 v[74:75], v[74:75], v[42:43]
    v_pk_mul_f32 v[76:77], v[76:77], v[44:45]
    v_pk_mul_f32 v[78:79], v[78:79], v[46:47]
    v_mfma_f32_32x32x16_bf16 v[104:119], v[96:99], v[132:135], v[104:119]
    v_cvt_pk_bf16_f32 v100, v72, v73
    v_cvt_pk_bf16_f32 v101, v74, v75
    v_cvt_pk_bf16_f32 v102, v76, v77
    v_cvt_pk_bf16_f32 v103, v78, v79
    s_nop 0
    s_add_u32 s42, s42, s42
    v_mfma_f32_32x32x16_bf16 v[104:119], v[100:103], v[136:139], v[104:119]
    s_cbranch_scc1 K2_l1w
K2_g1w:
    s_waitcnt vmcnt(2)
K2_g1:
    ds_read_b128 v[120:123], v4 offset:0
    ds_read_b128 v[124:127], v5 offset:0
    ds_read_u16 v24, v3 offset:12288
    ds_read_u16 v26, v3 offset:12544
    ds_read_b128 v[128:131], v2 offset:6144
    v_exp_f32 v64, v48
    v_mfma_f32_32x32x16_bf16 v[168:183], v[84:87], v[88:91], v[168:183]
    v_exp_f32 v65, v49
    v_exp_f32 v66, v50
    v_exp_f32 v67, v51
    v_exp_f32 v68, v52
    v_mfma_f32_16x16x32_bf16 v[184:187], v[84:87], v[92:95], v[184:187]
    v_exp_f32 v69, v53
    s_waitcnt lgkmcnt(0)
    v_mfma_f32_32x32x16_bf16 v[32:47], v[128:131], v[140:143], 0
    v_exp_f32 v70, v54
    v_exp_f32 v71, v55
    v_exp_f32 v72, v56
    v_mfma_f32_32x32x16_bf16 v[32:47], v[120:123], v[152:155], v[32:47]
    v_exp_f32 v73, v57
    v_exp_f32 v74, v58
    v_exp_f32 v75, v59
    v_mfma_f32_32x32x16_bf16 v[32:47], v[124:127], v[156:159], v[32:47]
    v_exp_f32 v76, v60
    v_exp_f32 v77, v61
    v_exp_f32 v78, v62
    v_exp_f32 v79, v63
    buffer_load_dwordx4 v[84:87], v11, s[28:31], s57 offen offset:2048
    buffer_load_dwordx4 v[24:25], s[32:35], 0 idxen offen offset:0  lds
    v_mfma_f32_32x32x16_bf16 v[64:79], v[80:83], v[80:83], v[64:79]
    buffer_load_dwordx4 v[26:27], s[32:35], 0 idxen offen offset:1024  lds
    ds_read_b64_tr_b16 v[132:133], v14 offset:3072
    ds_read_b64_tr_b16 v[134:135], v14 offset:3584
    ds_read_b64_tr_b16 v[136:137], v14 offset:4096
    ds_read_b64_tr_b16 v[138:139], v14 offset:4608
    ds_read_b128 v[88:91], v12 offset:64
    ds_read_b128 v[92:95], v13 offset:64
    s_nop 4
    v_rcp_f32 v64, v64
    v_rcp_f32 v65, v65
    v_rcp_f32 v66, v66
    v_rcp_f32 v67, v67
    v_rcp_f32 v68, v68
    v_rcp_f32 v69, v69
    v_rcp_f32 v70, v70
    v_rcp_f32 v71, v71
    v_rcp_f32 v72, v72
    v_rcp_f32 v73, v73
    v_rcp_f32 v74, v74
    v_rcp_f32 v75, v75
    v_rcp_f32 v76, v76
    v_rcp_f32 v77, v77
    v_rcp_f32 v78, v78
    v_rcp_f32 v79, v79
    s_waitcnt lgkmcnt(0)
    v_add_u32 v14, 6144, v14
    v_add_u32 v12, 64, v12
    v_add_u32 v13, 64, v13
    s_add_u32 s57, s57, 2048
    v_pk_mul_f32 v[64:65], v[64:65], v[48:49]
    v_pk_mul_f32 v[66:67], v[66:67], v[50:51]
    v_pk_mul_f32 v[68:69], v[68:69], v[52:53]
    v_pk_mul_f32 v[70:71], v[70:71], v[54:55]
    v_cvt_pk_bf16_f32 v96, v64, v65
    v_cvt_pk_bf16_f32 v97, v66, v67
    v_cvt_pk_bf16_f32 v98, v68, v69
    v_cvt_pk_bf16_f32 v99, v70, v71
    v_pk_mul_f32 v[72:73], v[72:73], v[56:57]
    v_pk_mul_f32 v[74:75], v[74:75], v[58:59]
    v_pk_mul_f32 v[76:77], v[76:77], v[60:61]
    v_pk_mul_f32 v[78:79], v[78:79], v[62:63]
    v_mfma_f32_32x32x16_bf16 v[104:119], v[96:99], v[132:135], v[104:119]
    v_cvt_pk_bf16_f32 v100, v72, v73
    v_cvt_pk_bf16_f32 v101, v74, v75
    v_cvt_pk_bf16_f32 v102, v76, v77
    v_cvt_pk_bf16_f32 v103, v78, v79
    v_add_u32 v2, 6144, v2
    v_add_u32 v3, 6144, v3
    s_add_u32 s42, s42, s42
    v_mfma_f32_32x32x16_bf16 v[104:119], v[100:103], v[136:139], v[104:119]
    s_cbranch_scc0 K2_g0w
K2_l0w:
    s_waitcnt vmcnt(2)
K2_l0:
    s_setprio 0
    s_mov_b32 s45, 1
    s_bitcmp0_b32 s43, 1
    s_cbranch_scc1 K2_l0_lo
    s_bitcmp0_b32 s43, 0
    s_cbranch_scc1 K2_l0_3
    ds_read_b128 v[120:123], v4 offset:2048
    ds_read_b128 v[124:127], v5 offset:2048
    ds_read_u16 v28, v3 offset:9216
    ds_read_u16 v30, v3 offset:9472
    ds_read_b128 v[128:131], v2 offset:3072
    v_mov_b64 v[96:97], v[140:141]
    v_mov_b64 v[140:141], v[144:145]
    v_mov_b64 v[144:145], v[146:147]
    v_mov_b64 v[146:147], v[148:149]
    v_mov_b64 v[148:149], v[150:151]
    v_mov_b64 v[150:151], v[96:97]
    v_exp_f32 v64, v32
    v_mfma_f32_32x32x16_bf16 v[168:183], v[84:87], v[88:91], v[168:183]
    v_exp_f32 v65, v33
    v_exp_f32 v66, v34
    v_exp_f32 v67, v35
    v_exp_f32 v68, v36
    v_mfma_f32_16x16x32_bf16 v[184:187], v[84:87], v[92:95], v[184:187]
    v_exp_f32 v69, v37
    s_waitcnt lgkmcnt(0)
    v_mfma_f32_32x32x16_bf16 v[48:63], v[128:131], v[140:143], 0
    v_exp_f32 v70, v38
    v_exp_f32 v71, v39
    v_exp_f32 v72, v40
    v_mfma_f32_32x32x16_bf16 v[48:63], v[120:123], v[152:155], v[48:63]
    v_exp_f32 v73, v41
    v_exp_f32 v74, v42
    v_exp_f32 v75, v43
    v_mfma_f32_32x32x16_bf16 v[48:63], v[124:127], v[156:159], v[48:63]
    v_exp_f32 v76, v44
    v_exp_f32 v77, v45
    v_exp_f32 v78, v46
    v_exp_f32 v79, v47
    buffer_load_dwordx4 v[84:87], v11, s[28:31], s57 offen offset:1024
    buffer_load_dwordx4 v[28:29], s[32:35], 0 idxen offen offset:2048  lds
    v_mfma_f32_32x32x16_bf16 v[64:79], v[80:83], v[80:83], v[64:79]
    buffer_load_dwordx4 v[30:31], s[32:35], 0 idxen offen offset:3072  lds
    ds_read_b64_tr_b16 v[132:133], v14 offset:0
    ds_read_b64_tr_b16 v[134:135], v14 offset:512
    ds_read_b64_tr_b16 v[136:137], v14 offset:1024
    ds_read_b64_tr_b16 v[138:139], v14 offset:1536
    ds_read_b128 v[88:91], v12 offset:32
    ds_read_b128 v[92:95], v13 offset:32
    s_nop 4
    v_rcp_f32 v64, v64
    v_rcp_f32 v65, v65
    v_rcp_f32 v66, v66
    v_rcp_f32 v67, v67
    v_rcp_f32 v68, v68
    v_rcp_f32 v69, v69
    v_rcp_f32 v70, v70
    v_rcp_f32 v71, v71
    v_rcp_f32 v72, v72
    v_rcp_f32 v73, v73
    v_rcp_f32 v74, v74
    v_rcp_f32 v75, v75
    v_rcp_f32 v76, v76
    v_rcp_f32 v77, v77
    v_rcp_f32 v78, v78
    v_rcp_f32 v79, v79
    s_waitcnt lgkmcnt(0)
    v_pk_mul_f32 v[64:65], v[64:65], v[32:33]
    v_pk_mul_f32 v[66:67], v[66:67], v[34:35]
    v_pk_mul_f32 v[68:69], v[68:69], v[36:37]
    v_pk_mul_f32 v[70:71], v[70:71], v[38:39]
    v_cvt_pk_bf16_f32 v96, v64, v65
    v_cvt_pk_bf16_f32 v97, v66, v67
    v_cvt_pk_bf16_f32 v98, v68, v69
    v_cvt_pk_bf16_f32 v99, v70, v71
    v_pk_mul_f32 v[72:73], v[72:73], v[40:41]
    v_pk_mul_f32 v[74:75], v[74:75], v[42:43]
    v_pk_mul_f32 v[76:77], v[76:77], v[44:45]
    v_pk_mul_f32 v[78:79], v[78:79], v[46:47]
    v_mfma_f32_32x32x16_bf16 v[104:119], v[96:99], v[132:135], v[104:119]
    v_cvt_pk_bf16_f32 v100, v72, v73
    v_cvt_pk_bf16_f32 v101, v74, v75
    v_cvt_pk_bf16_f32 v102, v76, v77
    v_cvt_pk_bf16_f32 v103, v78, v79
    s_nop 0
    s_nop 0
    v_mfma_f32_32x32x16_bf16 v[104:119], v[100:103], v[136:139], v[104:119]
    s_branch K2_flush
K2_l0_3:
    ds_read_b128 v[120:123], v4 offset:2048
    ds_read_b128 v[124:127], v5 offset:2048
    ds_read_u16 v28, v3 offset:9216
    ds_read_u16 v30, v3 offset:9472
    ds_read_b128 v[128:131], v2 offset:3072
    v_mov_b64 v[96:97], v[140:141]
    v_mov_b64 v[140:141], v[144:145]
    v_mov_b64 v[144:145], v[146:147]
    v_mov_b64 v[146:147], v[148:149]
    v_mov_b64 v[148:149], v[150:151]
    v_mov_b64 v[150:151], v[96:97]
    v_exp_f32 v64, v32
    v_mfma_f32_32x32x16_bf16 v[168:183], v[84:87], v[88:91], v[168:183]
    v_mfma_f32_16x16x32_bf16 v[184:187], v[84:87], v[92:95], v[184:187]
    v_exp_f32 v65, v33
    s_waitcnt lgkmcnt(0)
    v_mfma_f32_32x32x16_bf16 v[48:63], v[128:131], v[140:143], 0
    v_exp_f32 v66, v34
    v_exp_f32 v67, v35
    v_exp_f32 v68, v36
    v_mfma_f32_32x32x16_bf16 v[48:63], v[120:123], v[152:155], v[48:63]
    v_exp_f32 v69, v37
    v_exp_f32 v70, v38
    v_exp_f32 v71, v39
    v_mfma_f32_32x32x16_bf16 v[48:63], v[124:127], v[156:159], v[48:63]
    v_exp_f32 v72, v40
    v_exp_f32 v73, v41
    v_exp_f32 v74, v42
    v_exp_f32 v75, v43
    buffer_load_dwordx4 v[84:87], v11, s[28:31], s57 offen offset:1024
    buffer_load_dwordx4 v[28:29], s[32:35], 0 idxen offen offset:2048  lds
    v_mfma_f32_32x32x16_bf16 v[64:79], v[80:83], v[80:83], v[64:79]
    buffer_load_dwordx4 v[30:31], s[32:35], 0 idxen offen offset:3072  lds
    ds_read_b64_tr_b16 v[132:133], v14 offset:0
    ds_read_b64_tr_b16 v[134:135], v14 offset:512
    ds_read_b64_tr_b16 v[136:137], v14 offset:1024
    ds_read_b64_tr_b16 v[138:139], v14 offset:1536
    ds_read_b128 v[88:91], v12 offset:32
    ds_read_b128 v[92:95], v13 offset:32
    s_nop 4
    v_rcp_f32 v64, v64
    v_rcp_f32 v65, v65
    v_rcp_f32 v66, v66
    v_rcp_f32 v67, v67
    v_rcp_f32 v68, v68
    v_rcp_f32 v69, v69
    v_rcp_f32 v70, v70
    v_rcp_f32 v71, v71
    v_rcp_f32 v72, v72
    v_rcp_f32 v73, v73
    v_rcp_f32 v74, v74
    v_rcp_f32 v75, v75
    s_waitcnt lgkmcnt(0)
    v_pk_mul_f32 v[64:65], v[64:65], v[32:33]
    v_pk_mul_f32 v[66:67], v[66:67], v[34:35]
    v_pk_mul_f32 v[68:69], v[68:69], v[36:37]
    v_pk_mul_f32 v[70:71], v[70:71], v[38:39]
    v_pk_mul_f32 v[72:73], v[72:73], v[40:41]
    v_pk_mul_f32 v[74:75], v[74:75], v[42:43]
    v_cvt_pk_bf16_f32 v96, v64, v65
    v_cvt_pk_bf16_f32 v97, v66, v67
    v_cvt_pk_bf16_f32 v98, v68, v69
    v_cvt_pk_bf16_f32 v99, v70, v71
    v_cvt_pk_bf16_f32 v100, v72, v73
    v_cvt_pk_bf16_f32 v101, v74, v75
    v_mfma_f32_32x32x16_bf16 v[104:119], v[96:99], v[132:135], v[104:119]
    s_nop 1
    v_mfma_f32_32x32x16_bf16 v[104:119], v[100:103], v[136:139], v[104:119]
    s_branch K2_flush
K2_l0_lo:
    s_bitcmp0_b32 s43, 0
    s_cbranch_scc1 K2_l0_1
    ds_read_b128 v[120:123], v4 offset:2048
    ds_read_b128 v[124:127], v5 offset:2048
    ds_read_u16 v28, v3 offset:9216
    ds_read_u16 v30, v3 offset:9472
    v_exp_f32 v64, v32
    v_exp_f32 v65, v33
    v_mfma_f32_32x32x16_bf16 v[168:183], v[84:87], v[88:91], v[168:183]
    ds_read_b128 v[128:131], v2 offset:3072
    ds_read_b64_tr_b16 v[132:133], v14 offset:0
    ds_read_b64_tr_b16 v[134:135], v14 offset:512
    v_exp_f32 v66, v34
    v_exp_f32 v67, v35
    v_mfma_f32_16x16x32_bf16 v[184:187], v[84:87], v[92:95], v[184:187]
    v_exp_f32 v68, v36
    v_exp_f32 v69, v37
    buffer_load_dwordx4 v[84:87], v11, s[28:31], s57 offen offset:1024
    s_waitcnt lgkmcnt(3)
    buffer_load_dwordx4 v[28:29], s[32:35], 0 idxen offen offset:2048  lds
    buffer_load_dwordx4 v[30:31], s[32:35], 0 idxen offen offset:3072  lds
    ds_read_b128 v[88:91], v12 offset:32
    ds_read_b128 v[92:95], v13 offset:32
    v_exp_f32 v70, v38
    v_exp_f32 v71, v39
    v_pk_add_f32 v[64:65], v[64:65], 1.0 op_sel_hi:[1,0]
    v_pk_add_f32 v[66:67], v[66:67], 1.0 op_sel_hi:[1,0]
    v_pk_add_f32 v[68:69], v[68:69], 1.0 op_sel_hi:[1,0]
    v_pk_add_f32 v[70:71], v[70:71], 1.0 op_sel_hi:[1,0]
    v_mov_b64 v[96:97], v[140:141]
    v_mov_b64 v[140:141], v[144:145]
    v_mov_b64 v[144:145], v[146:147]
    v_mov_b64 v[146:147], v[148:149]
    v_mov_b64 v[148:149], v[150:151]
    v_mov_b64 v[150:151], v[96:97]
    s_waitcnt lgkmcnt(0)
    v_mfma_f32_32x32x16_bf16 v[48:63], v[128:131], v[140:143], 0
    v_rcp_f32 v64, v64
    v_rcp_f32 v65, v65
    v_rcp_f32 v66, v66
    v_mfma_f32_32x32x16_bf16 v[48:63], v[120:123], v[152:155], v[48:63]
    v_rcp_f32 v67, v67
    v_rcp_f32 v68, v68
    v_rcp_f32 v69, v69
    v_mfma_f32_32x32x16_bf16 v[48:63], v[124:127], v[156:159], v[48:63]
    v_rcp_f32 v70, v70
    v_rcp_f32 v71, v71
    v_pk_mul_f32 v[64:65], v[64:65], v[32:33]
    v_pk_mul_f32 v[66:67], v[66:67], v[34:35]
    v_pk_mul_f32 v[68:69], v[68:69], v[36:37]
    v_pk_mul_f32 v[70:71], v[70:71], v[38:39]
    v_cvt_pk_bf16_f32 v96, v64, v65
    v_cvt_pk_bf16_f32 v97, v66, v67
    v_cvt_pk_bf16_f32 v98, v68, v69
    v_cvt_pk_bf16_f32 v99, v70, v71
    s_nop 1
    v_mfma_f32_32x32x16_bf16 v[104:119], v[96:99], v[132:135], v[104:119]
    s_branch K2_flush
K2_l0_1:
    ds_read_b128 v[120:123], v4 offset:2048
    ds_read_b128 v[124:127], v5 offset:2048
    ds_read_u16 v28, v3 offset:9216
    ds_read_u16 v30, v3 offset:9472
    v_exp_f32 v64, v32
    v_mfma_f32_32x32x16_bf16 v[168:183], v[84:87], v[88:91], v[168:183]
    ds_read_b128 v[128:131], v2 offset:3072
    ds_read_b64_tr_b16 v[132:133], v14 offset:0
    ds_read_b64_tr_b16 v[134:135], v14 offset:512
    v_exp_f32 v65, v33
    v_mfma_f32_16x16x32_bf16 v[184:187], v[84:87], v[92:95], v[184:187]
    v_exp_f32 v66, v34
    v_exp_f32 v67, v35
    buffer_load_dwordx4 v[84:87], v11, s[28:31], s57 offen offset:1024
    s_waitcnt lgkmcnt(3)
    buffer_load_dwordx4 v[28:29], s[32:35], 0 idxen offen offset:2048  lds
    buffer_load_dwordx4 v[30:31], s[32:35], 0 idxen offen offset:3072  lds
    ds_read_b128 v[88:91], v12 offset:32
    ds_read_b128 v[92:95], v13 offset:32
    v_pk_add_f32 v[64:65], v[64:65], 1.0 op_sel_hi:[1,0]
    v_pk_add_f32 v[66:67], v[66:67], 1.0 op_sel_hi:[1,0]
    v_mov_b64 v[96:97], v[140:141]
    v_mov_b64 v[140:141], v[144:145]
    v_mov_b64 v[144:145], v[146:147]
    v_mov_b64 v[146:147], v[148:149]
    v_mov_b64 v[148:149], v[150:151]
    v_mov_b64 v[150:151], v[96:97]
    s_waitcnt lgkmcnt(0)
    v_mfma_f32_32x32x16_bf16 v[48:63], v[128:131], v[140:143], 0
    v_rcp_f32 v64, v64
    v_rcp_f32 v65, v65
    v_mfma_f32_32x32x16_bf16 v[48:63], v[120:123], v[152:155], v[48:63]
    v_rcp_f32 v66, v66
    v_rcp_f32 v67, v67
    v_mfma_f32_32x32x16_bf16 v[48:63], v[124:127], v[156:159], v[48:63]
    v_pk_mul_f32 v[64:65], v[64:65], v[32:33]
    v_pk_mul_f32 v[66:67], v[66:67], v[34:35]
    v_cvt_pk_bf16_f32 v96, v64, v65
    v_cvt_pk_bf16_f32 v97, v66, v67
    s_nop 1
    v_mfma_f32_32x32x16_bf16 v[104:119], v[96:99], v[132:135], v[104:119]
    s_branch K2_flush
K2_l1w:
    s_waitcnt vmcnt(2)
K2_l1:
    s_setprio 0
    s_mov_b32 s45, 0
    s_bitcmp0_b32 s43, 1
    s_cbranch_scc1 K2_l1_lo
    s_bitcmp0_b32 s43, 0
    s_cbranch_scc1 K2_l1_3
    ds_read_b128 v[120:123], v4 offset:0
    ds_read_b128 v[124:127], v5 offset:0
    ds_read_u16 v24, v3 offset:12288
    ds_read_u16 v26, v3 offset:12544
    ds_read_b128 v[128:131], v2 offset:6144
    v_mov_b64 v[96:97], v[140:141]
    v_mov_b64 v[140:141], v[144:145]
    v_mov_b64 v[144:145], v[146:147]
    v_mov_b64 v[146:147], v[148:149]
    v_mov_b64 v[148:149], v[150:151]
    v_mov_b64 v[150:151], v[96:97]
    v_exp_f32 v64, v48
    v_mfma_f32_32x32x16_bf16 v[168:183], v[84:87], v[88:91], v[168:183]
    v_exp_f32 v65, v49
    v_exp_f32 v66, v50
    v_exp_f32 v67, v51
    v_exp_f32 v68, v52
    v_mfma_f32_16x16x32_bf16 v[184:187], v[84:87], v[92:95], v[184:187]
    v_exp_f32 v69, v53
    s_waitcnt lgkmcnt(0)
    v_mfma_f32_32x32x16_bf16 v[32:47], v[128:131], v[140:143], 0
    v_exp_f32 v70, v54
    v_exp_f32 v71, v55
    v_exp_f32 v72, v56
    v_mfma_f32_32x32x16_bf16 v[32:47], v[120:123], v[152:155], v[32:47]
    v_exp_f32 v73, v57
    v_exp_f32 v74, v58
    v_exp_f32 v75, v59
    v_mfma_f32_32x32x16_bf16 v[32:47], v[124:127], v[156:159], v[32:47]
    v_exp_f32 v76, v60
    v_exp_f32 v77, v61
    v_exp_f32 v78, v62
    v_exp_f32 v79, v63
    buffer_load_dwordx4 v[84:87], v11, s[28:31], s57 offen offset:2048
    buffer_load_dwordx4 v[24:25], s[32:35], 0 idxen offen offset:0  lds
    v_mfma_f32_32x32x16_bf16 v[64:79], v[80:83], v[80:83], v[64:79]
    buffer_load_dwordx4 v[26:27], s[32:35], 0 idxen offen offset:1024  lds
    ds_read_b64_tr_b16 v[132:133], v14 offset:3072
    ds_read_b64_tr_b16 v[134:135], v14 offset:3584
    ds_read_b64_tr_b16 v[136:137], v14 offset:4096
    ds_read_b64_tr_b16 v[138:139], v14 offset:4608
    ds_read_b128 v[88:91], v12 offset:64
    ds_read_b128 v[92:95], v13 offset:64
    s_nop 4
    v_rcp_f32 v64, v64
    v_rcp_f32 v65, v65
    v_rcp_f32 v66, v66
    v_rcp_f32 v67, v67
    v_rcp_f32 v68, v68
    v_rcp_f32 v69, v69
    v_rcp_f32 v70, v70
    v_rcp_f32 v71, v71
    v_rcp_f32 v72, v72
    v_rcp_f32 v73, v73
    v_rcp_f32 v74, v74
    v_rcp_f32 v75, v75
    v_rcp_f32 v76, v76
    v_rcp_f32 v77, v77
    v_rcp_f32 v78, v78
    v_rcp_f32 v79, v79
    s_waitcnt lgkmcnt(0)
    v_add_u32 v14, 6144, v14
    v_add_u32 v12, 64, v12
    v_add_u32 v13, 64, v13
    s_add_u32 s57, s57, 2048
    v_pk_mul_f32 v[64:65], v[64:65], v[48:49]
    v_pk_mul_f32 v[66:67], v[66:67], v[50:51]
    v_pk_mul_f32 v[68:69], v[68:69], v[52:53]
    v_pk_mul_f32 v[70:71], v[70:71], v[54:55]
    v_cvt_pk_bf16_f32 v96, v64, v65
    v_cvt_pk_bf16_f32 v97, v66, v67
    v_cvt_pk_bf16_f32 v98, v68, v69
    v_cvt_pk_bf16_f32 v99, v70, v71
    v_pk_mul_f32 v[72:73], v[72:73], v[56:57]
    v_pk_mul_f32 v[74:75], v[74:75], v[58:59]
    v_pk_mul_f32 v[76:77], v[76:77], v[60:61]
    v_pk_mul_f32 v[78:79], v[78:79], v[62:63]
    v_mfma_f32_32x32x16_bf16 v[104:119], v[96:99], v[132:135], v[104:119]
    v_cvt_pk_bf16_f32 v100, v72, v73
    v_cvt_pk_bf16_f32 v101, v74, v75
    v_cvt_pk_bf16_f32 v102, v76, v77
    v_cvt_pk_bf16_f32 v103, v78, v79
    v_add_u32 v2, 6144, v2
    v_add_u32 v3, 6144, v3
    v_mfma_f32_32x32x16_bf16 v[104:119], v[100:103], v[136:139], v[104:119]
    s_branch K2_flush
K2_l1_3:
    ds_read_b128 v[120:123], v4 offset:0
    ds_read_b128 v[124:127], v5 offset:0
    ds_read_u16 v24, v3 offset:12288
    ds_read_u16 v26, v3 offset:12544
    ds_read_b128 v[128:131], v2 offset:6144
    v_mov_b64 v[96:97], v[140:141]
    v_mov_b64 v[140:141], v[144:145]
    v_mov_b64 v[144:145], v[146:147]
    v_mov_b64 v[146:147], v[148:149]
    v_mov_b64 v[148:149], v[150:151]
    v_mov_b64 v[150:151], v[96:97]
    v_exp_f32 v64, v48
    v_mfma_f32_32x32x16_bf16 v[168:183], v[84:87], v[88:91], v[168:183]
    v_mfma_f32_16x16x32_bf16 v[184:187], v[84:87], v[92:95], v[184:187]
    v_exp_f32 v65, v49
    s_waitcnt lgkmcnt(0)
    v_mfma_f32_32x32x16_bf16 v[32:47], v[128:131], v[140:143], 0
    v_exp_f32 v66, v50
    v_exp_f32 v67, v51
    v_exp_f32 v68, v52
    v_mfma_f32_32x32x16_bf16 v[32:47], v[120:123], v[152:155], v[32:47]
    v_exp_f32 v69, v53
    v_exp_f32 v70, v54
    v_exp_f32 v71, v55
    v_mfma_f32_32x32x16_bf16 v[32:47], v[124:127], v[156:159], v[32:47]
    v_exp_f32 v72, v56
    v_exp_f32 v73, v57
    v_exp_f32 v74, v58
    v_exp_f32 v75, v59
    buffer_load_dwordx4 v[84:87], v11, s[28:31], s57 offen offset:2048
    buffer_load_dwordx4 v[24:25], s[32:35], 0 idxen offen offset:0  lds
    v_mfma_f32_32x32x16_bf16 v[64:79], v[80:83], v[80:83], v[64:79]
    buffer_load_dwordx4 v[26:27], s[32:35], 0 idxen offen offset:1024  lds
    ds_read_b64_tr_b16 v[132:133], v14 offset:3072
    ds_read_b64_tr_b16 v[134:135], v14 offset:3584
    ds_read_b64_tr_b16 v[136:137], v14 offset:4096
    ds_read_b64_tr_b16 v[138:139], v14 offset:4608
    ds_read_b128 v[88:91], v12 offset:64
    ds_read_b128 v[92:95], v13 offset:64
    s_nop 4
    v_rcp_f32 v64, v64
    v_rcp_f32 v65, v65
    v_rcp_f32 v66, v66
    v_rcp_f32 v67, v67
    v_rcp_f32 v68, v68
    v_rcp_f32 v69, v69
    v_rcp_f32 v70, v70
    v_rcp_f32 v71, v71
    v_rcp_f32 v72, v72
    v_rcp_f32 v73, v73
    v_rcp_f32 v74, v74
    v_rcp_f32 v75, v75
    s_waitcnt lgkmcnt(0)
    v_add_u32 v14, 6144, v14
    v_add_u32 v12, 64, v12
    v_add_u32 v13, 64, v13
    s_add_u32 s57, s57, 2048
    v_pk_mul_f32 v[64:65], v[64:65], v[48:49]
    v_pk_mul_f32 v[66:67], v[66:67], v[50:51]
    v_pk_mul_f32 v[68:69], v[68:69], v[52:53]
    v_pk_mul_f32 v[70:71], v[70:71], v[54:55]
    v_pk_mul_f32 v[72:73], v[72:73], v[56:57]
    v_pk_mul_f32 v[74:75], v[74:75], v[58:59]
    v_cvt_pk_bf16_f32 v96, v64, v65
    v_cvt_pk_bf16_f32 v97, v66, v67
    v_cvt_pk_bf16_f32 v98, v68, v69
    v_cvt_pk_bf16_f32 v99, v70, v71
    v_cvt_pk_bf16_f32 v100, v72, v73
    v_cvt_pk_bf16_f32 v101, v74, v75
    v_mfma_f32_32x32x16_bf16 v[104:119], v[96:99], v[132:135], v[104:119]
    v_add_u32 v2, 6144, v2
    v_add_u32 v3, 6144, v3
    v_mfma_f32_32x32x16_bf16 v[104:119], v[100:103], v[136:139], v[104:119]
    s_branch K2_flush
K2_l1_lo:
    s_bitcmp0_b32 s43, 0
    s_cbranch_scc1 K2_l1_1
    ds_read_b128 v[120:123], v4 offset:0
    ds_read_b128 v[124:127], v5 offset:0
    ds_read_u16 v24, v3 offset:12288
    ds_read_u16 v26, v3 offset:12544
    v_exp_f32 v64, v48
    v_exp_f32 v65, v49
    v_mfma_f32_32x32x16_bf16 v[168:183], v[84:87], v[88:91], v[168:183]
    ds_read_b128 v[128:131], v2 offset:6144
    ds_read_b64_tr_b16 v[132:133], v14 offset:3072
    ds_read_b64_tr_b16 v[134:135], v14 offset:3584
    v_exp_f32 v66, v50
    v_exp_f32 v67, v51
    v_mfma_f32_16x16x32_bf16 v[184:187], v[84:87], v[92:95], v[184:187]
    v_exp_f32 v68, v52
    v_exp_f32 v69, v53
    buffer_load_dwordx4 v[84:87], v11, s[28:31], s57 offen offset:2048
    s_waitcnt lgkmcnt(3)
    buffer_load_dwordx4 v[24:25], s[32:35], 0 idxen offen offset:0  lds
    buffer_load_dwordx4 v[26:27], s[32:35], 0 idxen offen offset:1024  lds
    ds_read_b128 v[88:91], v12 offset:64
    ds_read_b128 v[92:95], v13 offset:64
    v_exp_f32 v70, v54
    v_exp_f32 v71, v55
    v_pk_add_f32 v[64:65], v[64:65], 1.0 op_sel_hi:[1,0]
    v_pk_add_f32 v[66:67], v[66:67], 1.0 op_sel_hi:[1,0]
    v_pk_add_f32 v[68:69], v[68:69], 1.0 op_sel_hi:[1,0]
    v_pk_add_f32 v[70:71], v[70:71], 1.0 op_sel_hi:[1,0]
    v_mov_b64 v[96:97], v[140:141]
    v_mov_b64 v[140:141], v[144:145]
    v_mov_b64 v[144:145], v[146:147]
    v_mov_b64 v[146:147], v[148:149]
    v_mov_b64 v[148:149], v[150:151]
    v_mov_b64 v[150:151], v[96:97]
    s_waitcnt lgkmcnt(0)
    v_mfma_f32_32x32x16_bf16 v[32:47], v[128:131], v[140:143], 0
    v_rcp_f32 v64, v64
    v_rcp_f32 v65, v65
    v_rcp_f32 v66, v66
    v_mfma_f32_32x32x16_bf16 v[32:47], v[120:123], v[152:155], v[32:47]
    v_rcp_f32 v67, v67
    v_rcp_f32 v68, v68
    v_rcp_f32 v69, v69
    v_mfma_f32_32x32x16_bf16 v[32:47], v[124:127], v[156:159], v[32:47]
    v_rcp_f32 v70, v70
    v_rcp_f32 v71, v71
    v_add_u32 v14, 6144, v14
    v_add_u32 v12, 64, v12
    v_add_u32 v13, 64, v13
    s_add_u32 s57, s57, 2048
    v_pk_mul_f32 v[64:65], v[64:65], v[48:49]
    v_pk_mul_f32 v[66:67], v[66:67], v[50:51]
    v_pk_mul_f32 v[68:69], v[68:69], v[52:53]
    v_pk_mul_f32 v[70:71], v[70:71], v[54:55]
    v_cvt_pk_bf16_f32 v96, v64, v65
    v_cvt_pk_bf16_f32 v97, v66, v67
    v_cvt_pk_bf16_f32 v98, v68, v69
    v_cvt_pk_bf16_f32 v99, v70, v71
    v_add_u32 v2, 6144, v2
    v_add_u32 v3, 6144, v3
    v_mfma_f32_32x32x16_bf16 v[104:119], v[96:99], v[132:135], v[104:119]
    s_branch K2_flush
K2_l1_1:
    ds_read_b128 v[120:123], v4 offset:0
    ds_read_b128 v[124:127], v5 offset:0
    ds_read_u16 v24, v3 offset:12288
    ds_read_u16 v26, v3 offset:12544
    v_exp_f32 v64, v48
    v_mfma_f32_32x32x16_bf16 v[168:183], v[84:87], v[88:91], v[168:183]
    ds_read_b128 v[128:131], v2 offset:6144
    ds_read_b64_tr_b16 v[132:133], v14 offset:3072
    ds_read_b64_tr_b16 v[134:135], v14 offset:3584
    v_exp_f32 v65, v49
    v_mfma_f32_16x16x32_bf16 v[184:187], v[84:87], v[92:95], v[184:187]
    v_exp_f32 v66, v50
    v_exp_f32 v67, v51
    buffer_load_dwordx4 v[84:87], v11, s[28:31], s57 offen offset:2048
    s_waitcnt lgkmcnt(3)
    buffer_load_dwordx4 v[24:25], s[32:35], 0 idxen offen offset:0  lds
    buffer_load_dwordx4 v[26:27], s[32:35], 0 idxen offen offset:1024  lds
    ds_read_b128 v[88:91], v12 offset:64
    ds_read_b128 v[92:95], v13 offset:64
    v_pk_add_f32 v[64:65], v[64:65], 1.0 op_sel_hi:[1,0]
    v_pk_add_f32 v[66:67], v[66:67], 1.0 op_sel_hi:[1,0]
    v_mov_b64 v[96:97], v[140:141]
    v_mov_b64 v[140:141], v[144:145]
    v_mov_b64 v[144:145], v[146:147]
    v_mov_b64 v[146:147], v[148:149]
    v_mov_b64 v[148:149], v[150:151]
    v_mov_b64 v[150:151], v[96:97]
    s_waitcnt lgkmcnt(0)
    v_mfma_f32_32x32x16_bf16 v[32:47], v[128:131], v[140:143], 0
    v_rcp_f32 v64, v64
    v_rcp_f32 v65, v65
    v_mfma_f32_32x32x16_bf16 v[32:47], v[120:123], v[152:155], v[32:47]
    v_rcp_f32 v66, v66
    v_rcp_f32 v67, v67
    v_mfma_f32_32x32x16_bf16 v[32:47], v[124:127], v[156:159], v[32:47]
    v_add_u32 v14, 6144, v14
    v_add_u32 v12, 64, v12
    v_add_u32 v13, 64, v13
    s_add_u32 s57, s57, 2048
    v_pk_mul_f32 v[64:65], v[64:65], v[48:49]
    v_pk_mul_f32 v[66:67], v[66:67], v[50:51]
    v_cvt_pk_bf16_f32 v96, v64, v65
    v_cvt_pk_bf16_f32 v97, v66, v67
    v_add_u32 v2, 6144, v2
    v_add_u32 v3, 6144, v3
    v_mfma_f32_32x32x16_bf16 v[104:119], v[96:99], v[132:135], v[104:119]
K2_flush:
    s_lshr_b32 s43, s43, 2
    s_add_u32 s44, s44, 1
K2_flush2:
    s_cmp_eq_u32 s44, 1
    s_cbranch_scc1 K2_x0
    s_cmp_eq_u32 s44, 2
    s_cbranch_scc1 K2_x1
    s_cmp_eq_u32 s44, 3
    s_cbranch_scc1 K2_x2
    s_cmp_eq_u32 s44, 4
    s_cbranch_scc1 K2_x3
    s_cmp_lg_u32 s44, 5
    s_cbranch_scc1 K2_slowflush
    v_cvt_pk_bf16_f32 v64, v104, v105
    v_cvt_pk_bf16_f32 v65, v106, v107
    v_cvt_pk_bf16_f32 v66, v108, v109
    v_cvt_pk_bf16_f32 v67, v110, v111
    v_cvt_pk_bf16_f32 v68, v112, v113
    v_cvt_pk_bf16_f32 v69, v114, v115
    v_cvt_pk_bf16_f32 v70, v116, v117
    v_cvt_pk_bf16_f32 v71, v118, v119
    s_mov_b64 exec, s[62:63]
    ds_write_b64 v6, v[64:65] offset:16896
    ds_write_b64 v6, v[66:67] offset:16912
    ds_write_b64 v6, v[68:69] offset:16928
    ds_write_b64 v6, v[70:71] offset:16944
    s_mov_b64 exec, -1
    v_dot2_f32_bf16 v72, v64, v160, 0
    v_dot2_f32_bf16 v72, v65, v161, v72
    v_dot2_f32_bf16 v72, v66, v162, v72
    v_dot2_f32_bf16 v72, v67, v163, v72
    v_dot2_f32_bf16 v72, v68, v164, v72
    v_dot2_f32_bf16 v72, v69, v165, v72
    v_dot2_f32_bf16 v72, v70, v166, v72
    v_dot2_f32_bf16 v72, v71, v167, v72
    s_lshl_b32 s38, s45, 10
    s_add_u32 s57, s57, s38
    s_cmp_lt_u32 s57, 16384
    s_cbranch_scc1 K2_crest
K2_cdone:
    ds_read_b64 v[120:121], v9 offset:0
    ds_read_b64 v[122:123], v9 offset:16
    ds_read_b64 v[124:125], v9 offset:32
    ds_read_b64 v[126:127], v9 offset:48
    ds_read_b64 v[128:129], v10
    v_cmp_ne_u32 vcc, 64, v8
    v_add_u32 v7, 21632, v7
    v_add_u32 v146, 21632, v8
    v_cndmask_b32_e64 v8, v8, v146, vcc
    v_lshl_add_u32 v146, v1, 2, s55
    s_waitcnt vmcnt(0)
    ds_write2st64_b32 v146, v19, v20 offset0:0 offset1:1
    ds_write2st64_b32 v146, v21, v22 offset0:2 offset1:3
    ds_write_b32 v146, v72 offset:1024
    v_pk_mul_f32 v[168:169], v[168:169], s[64:65] op_sel_hi:[1,0]
    v_pk_mul_f32 v[170:171], v[170:171], s[64:65] op_sel_hi:[1,0]
    v_pk_mul_f32 v[172:173], v[172:173], s[64:65] op_sel_hi:[1,0]
    v_pk_mul_f32 v[174:175], v[174:175], s[64:65] op_sel_hi:[1,0]
    v_pk_mul_f32 v[176:177], v[176:177], s[64:65] op_sel_hi:[1,0]
    v_pk_mul_f32 v[178:179], v[178:179], s[64:65] op_sel_hi:[1,0]
    v_pk_mul_f32 v[180:181], v[180:181], s[64:65] op_sel_hi:[1,0]
    v_pk_mul_f32 v[182:183], v[182:183], s[64:65] op_sel_hi:[1,0]
    v_pk_mul_f32 v[184:185], v[184:185], s[64:65] op_sel_hi:[1,0]
    v_pk_mul_f32 v[186:187], v[186:187], s[64:65] op_sel_hi:[1,0]
    s_waitcnt lgkmcnt(0)
    s_barrier
    s_setprio 2
    ds_read_b128 v[32:35], v7 offset:0
    ds_read_b128 v[36:39], v8 offset:0
    ds_read_b128 v[40:43], v7 offset:32
    ds_read_b128 v[44:47], v8 offset:32
    ds_read_b128 v[48:51], v7 offset:64
    ds_read_b128 v[52:55], v8 offset:64
    ds_read_b128 v[56:59], v7 offset:96
    ds_read_b128 v[60:63], v8 offset:96
    s_waitcnt lgkmcnt(6)
    v_mfma_f32_32x32x16_bf16 v[168:183], v[188:191], v[32:35], v[168:183]
    ds_read_b128 v[64:67], v7 offset:128
    ds_read_b128 v[68:71], v8 offset:128
    s_waitcnt lgkmcnt(6)
    v_mfma_f32_16x16x32_bf16 v[184:187], v[188:191], v[36:39], v[184:187]
    v_mfma_f32_32x32x16_bf16 v[168:183], v[192:195], v[40:43], v[168:183]
    ds_read_b128 v[32:35], v7 offset:160
    ds_read_b128 v[36:39], v8 offset:160
    s_waitcnt lgkmcnt(6)
    v_mfma_f32_16x16x32_bf16 v[184:187], v[192:195], v[44:47], v[184:187]
    v_mfma_f32_32x32x16_bf16 v[168:183], v[196:199], v[48:51], v[168:183]
    ds_read_b128 v[40:43], v7 offset:192
    ds_read_b128 v[44:47], v8 offset:192
    s_waitcnt lgkmcnt(6)
    v_mfma_f32_16x16x32_bf16 v[184:187], v[196:199], v[52:55], v[184:187]
    v_mfma_f32_32x32x16_bf16 v[168:183], v[200:203], v[56:59], v[168:183]
    ds_read_b128 v[48:51], v7 offset:224
    ds_read_b128 v[52:55], v8 offset:224
    s_waitcnt lgkmcnt(6)
    v_mfma_f32_16x16x32_bf16 v[184:187], v[200:203], v[60:63], v[184:187]
    v_mfma_f32_32x32x16_bf16 v[168:183], v[204:207], v[64:67], v[168:183]
    ds_read_b128 v[56:59], v7 offset:256
    ds_read_b128 v[60:63], v8 offset:256
    s_waitcnt lgkmcnt(6)
    v_mfma_f32_16x16x32_bf16 v[184:187], v[204:207], v[68:71], v[184:187]
    v_mfma_f32_32x32x16_bf16 v[168:183], v[208:211], v[32:35], v[168:183]
    ds_read_b128 v[64:67], v7 offset:288
    ds_read_b128 v[68:71], v8 offset:288
    s_waitcnt lgkmcnt(6)
    v_mfma_f32_16x16x32_bf16 v[184:187], v[208:211], v[36:39], v[184:187]
    v_mfma_f32_32x32x16_bf16 v[168:183], v[212:215], v[40:43], v[168:183]
    ds_read_b128 v[32:35], v7 offset:320
    ds_read_b128 v[36:39], v8 offset:320
    s_waitcnt lgkmcnt(6)
    v_mfma_f32_16x16x32_bf16 v[184:187], v[212:215], v[44:47], v[184:187]
    v_mfma_f32_32x32x16_bf16 v[168:183], v[216:219], v[48:51], v[168:183]
    ds_read_b128 v[40:43], v7 offset:352
    ds_read_b128 v[44:47], v8 offset:352
    s_waitcnt lgkmcnt(6)
    v_mfma_f32_16x16x32_bf16 v[184:187], v[216:219], v[52:55], v[184:187]
    v_mfma_f32_32x32x16_bf16 v[168:183], v[220:223], v[56:59], v[168:183]
    ds_read_b128 v[48:51], v7 offset:384
    ds_read_b128 v[52:55], v8 offset:384
    s_waitcnt lgkmcnt(6)
    v_mfma_f32_16x16x32_bf16 v[184:187], v[220:223], v[60:63], v[184:187]
    v_mfma_f32_32x32x16_bf16 v[168:183], v[224:227], v[64:67], v[168:183]
    ds_read_b128 v[56:59], v7 offset:416
    ds_read_b128 v[60:63], v8 offset:416
    s_waitcnt lgkmcnt(6)
    v_mfma_f32_16x16x32_bf16 v[184:187], v[224:227], v[68:71], v[184:187]
    v_mfma_f32_32x32x16_bf16 v[168:183], v[228:231], v[32:35], v[168:183]
    ds_read_b128 v[64:67], v7 offset:448
    ds_read_b128 v[68:71], v8 offset:448
    s_waitcnt lgkmcnt(6)
    v_mfma_f32_16x16x32_bf16 v[184:187], v[228:231], v[36:39], v[184:187]
    v_mfma_f32_32x32x16_bf16 v[168:183], v[232:235], v[40:43], v[168:183]
    ds_read_b128 v[32:35], v7 offset:480
    ds_read_b128 v[36:39], v8 offset:480
    s_waitcnt lgkmcnt(6)
    v_mfma_f32_16x16x32_bf16 v[184:187], v[232:235], v[44:47], v[184:187]
    v_mfma_f32_32x32x16_bf16 v[168:183], v[236:239], v[48:51], v[168:183]
    s_waitcnt lgkmcnt(4)
    v_mfma_f32_16x16x32_bf16 v[184:187], v[236:239], v[52:55], v[184:187]
    v_mfma_f32_32x32x16_bf16 v[168:183], v[240:243], v[56:59], v[168:183]
    s_waitcnt lgkmcnt(2)
    v_mfma_f32_16x16x32_bf16 v[184:187], v[240:243], v[60:63], v[184:187]
    v_mfma_f32_32x32x16_bf16 v[168:183], v[244:247], v[64:67], v[168:183]
    s_waitcnt lgkmcnt(0)
    v_mfma_f32_16x16x32_bf16 v[184:187], v[244:247], v[68:71], v[184:187]
    v_mfma_f32_32x32x16_bf16 v[168:183], v[248:251], v[32:35], v[168:183]
    v_mfma_f32_16x16x32_bf16 v[184:187], v[248:251], v[36:39], v[184:187]
    s_setprio 0
    v_lshlrev_b32 v104, 16, v120
    v_and_b32 v105, 0xffff0000, v120
    v_lshlrev_b32 v106, 16, v121
    v_and_b32 v107, 0xffff0000, v121
    v_lshlrev_b32 v108, 16, v122
    v_and_b32 v109, 0xffff0000, v122
    v_lshlrev_b32 v110, 16, v123
    v_and_b32 v111, 0xffff0000, v123
    v_lshlrev_b32 v112, 16, v124
    v_and_b32 v113, 0xffff0000, v124
    v_lshlrev_b32 v114, 16, v125
    v_and_b32 v115, 0xffff0000, v125
    v_lshlrev_b32 v116, 16, v126
    v_and_b32 v117, 0xffff0000, v126
    v_lshlrev_b32 v118, 16, v127
    v_and_b32 v119, 0xffff0000, v127
    v_lshlrev_b32 v96, 16, v128
    v_and_b32 v97, 0xffff0000, v128
    v_lshlrev_b32 v98, 16, v129
    v_and_b32 v99, 0xffff0000, v129
    s_mov_b32 s40, 0xbf317218
    v_exp_f32 v32, v168
    v_exp_f32 v33, v169
    v_exp_f32 v34, v170
    v_exp_f32 v35, v171
    v_exp_f32 v36, v172
    v_exp_f32 v37, v173
    v_exp_f32 v38, v174
    v_exp_f32 v39, v175
    v_exp_f32 v40, v176
    v_exp_f32 v41, v177
    v_exp_f32 v42, v178
    v_exp_f32 v43, v179
    v_exp_f32 v44, v180
    v_exp_f32 v45, v181
    v_exp_f32 v46, v182
    v_exp_f32 v47, v183
    v_exp_f32 v48, v184
    v_exp_f32 v49, v185
    v_exp_f32 v50, v186
    v_exp_f32 v51, v187
    v_pk_add_f32 v[32:33], v[32:33], 1.0 op_sel_hi:[1,0]
    v_pk_add_f32 v[34:35], v[34:35], 1.0 op_sel_hi:[1,0]
    v_pk_add_f32 v[36:37], v[36:37], 1.0 op_sel_hi:[1,0]
    v_pk_add_f32 v[38:39], v[38:39], 1.0 op_sel_hi:[1,0]
    v_pk_add_f32 v[40:41], v[40:41], 1.0 op_sel_hi:[1,0]
    v_pk_add_f32 v[42:43], v[42:43], 1.0 op_sel_hi:[1,0]
    v_pk_add_f32 v[44:45], v[44:45], 1.0 op_sel_hi:[1,0]
    v_pk_add_f32 v[46:47], v[46:47], 1.0 op_sel_hi:[1,0]
    v_pk_add_f32 v[48:49], v[48:49], 1.0 op_sel_hi:[1,0]
    v_pk_add_f32 v[50:51], v[50:51], 1.0 op_sel_hi:[1,0]
    v_rcp_f32 v32, v32
    v_rcp_f32 v33, v33
    v_rcp_f32 v34, v34
    v_rcp_f32 v35, v35
    v_rcp_f32 v36, v36
    v_rcp_f32 v37, v37
    v_rcp_f32 v38, v38
    v_rcp_f32 v39, v39
    v_rcp_f32 v40, v40
    v_rcp_f32 v41, v41
    v_rcp_f32 v42, v42
    v_rcp_f32 v43, v43
    v_rcp_f32 v44, v44
    v_rcp_f32 v45, v45
    v_rcp_f32 v46, v46
    v_rcp_f32 v47, v47
    v_rcp_f32 v48, v48
    v_rcp_f32 v49, v49
    v_rcp_f32 v50, v50
    v_rcp_f32 v51, v51
    v_pk_mul_f32 v[32:33], v[32:33], v[168:169]
    v_pk_mul_f32 v[34:35], v[34:35], v[170:171]
    v_pk_mul_f32 v[36:37], v[36:37], v[172:173]
    v_pk_mul_f32 v[38:39], v[38:39], v[174:175]
    v_pk_mul_f32 v[40:41], v[40:41], v[176:177]
    v_pk_mul_f32 v[42:43], v[42:43], v[178:179]
    v_pk_mul_f32 v[44:45], v[44:45], v[180:181]
    v_pk_mul_f32 v[46:47], v[46:47], v[182:183]
    v_pk_mul_f32 v[48:49], v[48:49], v[184:185]
    v_pk_mul_f32 v[50:51], v[50:51], v[186:187]
    v_pk_fma_f32 v[32:33], v[32:33], s[40:41], v[104:105] op_sel_hi:[1,0,1]
    v_pk_fma_f32 v[34:35], v[34:35], s[40:41], v[106:107] op_sel_hi:[1,0,1]
    v_pk_fma_f32 v[36:37], v[36:37], s[40:41], v[108:109] op_sel_hi:[1,0,1]
    v_pk_fma_f32 v[38:39], v[38:39], s[40:41], v[110:111] op_sel_hi:[1,0,1]
    v_pk_fma_f32 v[40:41], v[40:41], s[40:41], v[112:113] op_sel_hi:[1,0,1]
    v_pk_fma_f32 v[42:43], v[42:43], s[40:41], v[114:115] op_sel_hi:[1,0,1]
    v_pk_fma_f32 v[44:45], v[44:45], s[40:41], v[116:117] op_sel_hi:[1,0,1]
    v_pk_fma_f32 v[46:47], v[46:47], s[40:41], v[118:119] op_sel_hi:[1,0,1]
    v_pk_fma_f32 v[48:49], v[48:49], s[40:41], v[96:97] op_sel_hi:[1,0,1]
    v_pk_fma_f32 v[50:51], v[50:51], s[40:41], v[98:99] op_sel_hi:[1,0,1]
    v_cvt_pk_bf16_f32 v64, v32, v33
    v_cvt_pk_bf16_f32 v65, v34, v35
    v_cvt_pk_bf16_f32 v66, v36, v37
    v_cvt_pk_bf16_f32 v67, v38, v39
    v_cvt_pk_bf16_f32 v68, v40, v41
    v_cvt_pk_bf16_f32 v69, v42, v43
    v_cvt_pk_bf16_f32 v70, v44, v45
    v_cvt_pk_bf16_f32 v71, v46, v47
    v_cvt_pk_bf16_f32 v72, v48, v49
    v_cvt_pk_bf16_f32 v73, v50, v51
    ds_write_b64 v9, v[64:65] offset:0
    ds_write_b64 v9, v[66:67] offset:16
    ds_write_b64 v9, v[68:69] offset:32
    ds_write_b64 v9, v[70:71] offset:48
    ds_write_b64 v10, v[72:73]
    v_lshrrev_b32 v146, 5, v0
    v_and_b32 v147, 31, v0
    v_mul_u32_u24 v146, 528, v146
    v_lshl_add_u32 v146, v147, 4, v146
    s_mul_i32 s39, s36, 20480
    v_lshl_add_u32 v147, v0, 4, s39
    v_add_u32 v148, 8192, v147
    v_add_u32 v149, 16384, v147
    s_cmp_ge_u32 s37, 2
    s_cbranch_scc1 K2_nopp
    v_min_u32 v144, 119, v0
    v_mul_u32_u24 v145, 171, v144
    v_lshrrev_b32 v145, 9, v145
    v_add3_u32 v145, v144, v145, 1
    v_lshrrev_b32 v80, 5, v145
    v_lshlrev_b32 v145, 2, v145
    ds_read_b32 v132, v145 offset:1020
    v_lshl_add_u32 v145, v80, 7, v145
    v_add_u32 v145, 127744, v145
    v_add_u32 v80, 128, v145
    ds_read2st64_b32 v[168:169], v145 offset0:0 offset1:16
    ds_read2st64_b32 v[170:171], v80 offset0:0 offset1:16
    ds_read2st64_b32 v[172:173], v145 offset0:32 offset1:48
    ds_read2st64_b32 v[174:175], v80 offset0:32 offset1:48
    ds_read2st64_b32 v[176:177], v145 offset0:64 offset1:80
    ds_read2st64_b32 v[178:179], v80 offset0:64 offset1:80
    ds_read2st64_b32 v[180:181], v145 offset0:96 offset1:112
    ds_read2st64_b32 v[182:183], v80 offset0:96 offset1:112
    s_mul_i32 s38, s36, 240
    s_add_u32 s38, s38, 5120000
    v_lshl_add_u32 v144, v144, 1, s38
    v_cmp_gt_u32 vcc, 120, v0
    s_waitcnt lgkmcnt(0)
    v_pk_add_f32 v[168:169], v[168:169], v[176:177]
    v_pk_add_f32 v[170:171], v[170:171], v[178:179]
    v_pk_add_f32 v[172:173], v[172:173], v[180:181]
    v_pk_add_f32 v[174:175], v[174:175], v[182:183]
    v_pk_add_f32 v[168:169], v[168:169], v[172:173]
    v_pk_add_f32 v[170:171], v[170:171], v[174:175]
    v_pk_add_f32 v[168:169], v[168:169], v[170:171]
    v_add_f32 v145, v168, v169
    v_fma_f32 v145, v145, s40, v132
    v_cvt_pk_bf16_f32 v145, v145, v145
    s_mov_b64 exec, vcc
    global_store_short v144, v145, s[20:21] sc1
    s_mov_b64 exec, -1
K2_nopp:
    s_waitcnt lgkmcnt(0)
    s_barrier
    ds_read_b128 v[32:35], v146 offset:2048
    ds_read_b128 v[36:39], v146 offset:10496
    s_cmp_ge_u32 s37, 4
    s_cbranch_scc1 K2_o2
    ds_read_b128 v[40:43], v146 offset:18944
    s_waitcnt lgkmcnt(0)
    global_store_dwordx4 v149, v[40:43], s[20:21] sc1
K2_o2:
    s_waitcnt lgkmcnt(0)
    global_store_dwordx4 v147, v[32:35], s[20:21] sc1
    global_store_dwordx4 v148, v[36:39], s[20:21] sc1
K2_exit:
    s_endpgm
K2_x0:
    s_add_u32 s54, s56, 262144
    buffer_load_dwordx4 v[188:191], v11, s[24:27], s54 offen offset:0
    buffer_load_dwordx4 v[192:195], v11, s[24:27], s54 offen offset:1024
    buffer_load_dwordx4 v[196:199], v11, s[24:27], s54 offen offset:2048
    buffer_load_dwordx4 v[200:203], v11, s[24:27], s54 offen offset:3072
    s_nop 2
    v_cvt_pk_bf16_f32 v64, v104, v105
    v_cvt_pk_bf16_f32 v65, v106, v107
    v_cvt_pk_bf16_f32 v66, v108, v109
    v_cvt_pk_bf16_f32 v67, v110, v111
    v_cvt_pk_bf16_f32 v68, v112, v113
    v_cvt_pk_bf16_f32 v69, v114, v115
    v_cvt_pk_bf16_f32 v70, v116, v117
    v_cvt_pk_bf16_f32 v71, v118, v119
    s_mov_b64 exec, s[62:63]
    ds_write_b64 v6, v[64:65] offset:0
    ds_write_b64 v6, v[66:67] offset:16
    ds_write_b64 v6, v[68:69] offset:32
    ds_write_b64 v6, v[70:71] offset:48
    s_mov_b64 exec, -1
    v_dot2_f32_bf16 v19, v64, v160, 0
    v_dot2_f32_bf16 v19, v65, v161, v19
    v_dot2_f32_bf16 v19, v66, v162, v19
    v_dot2_f32_bf16 v19, v67, v163, v19
    v_dot2_f32_bf16 v19, v68, v164, v19
    v_dot2_f32_bf16 v19, v69, v165, v19
    v_dot2_f32_bf16 v19, v70, v166, v19
    v_dot2_f32_bf16 v19, v71, v167, v19
    v_mov_b64 v[104:105], 0
    v_mov_b64 v[106:107], 0
    v_mov_b64 v[108:109], 0
    v_mov_b64 v[110:111], 0
    v_mov_b64 v[112:113], 0
    v_mov_b64 v[114:115], 0
    v_mov_b64 v[116:117], 0
    v_mov_b64 v[118:119], 0
    s_waitcnt vmcnt(6)
    s_branch K2_next
K2_x1:
    s_add_u32 s54, s56, 266240
    buffer_load_dwordx4 v[204:207], v11, s[24:27], s54 offen offset:0
    buffer_load_dwordx4 v[208:211], v11, s[24:27], s54 offen offset:1024
    buffer_load_dwordx4 v[212:215], v11, s[24:27], s54 offen offset:2048
    buffer_load_dwordx4 v[216:219], v11, s[24:27], s54 offen offset:3072
    s_nop 0
    v_cvt_pk_bf16_f32 v64, v104, v105
    v_cvt_pk_bf16_f32 v65, v106, v107
    v_cvt_pk_bf16_f32 v66, v108, v109
    v_cvt_pk_bf16_f32 v67, v110, v111
    v_cvt_pk_bf16_f32 v68, v112, v113
    v_cvt_pk_bf16_f32 v69, v114, v115
    v_cvt_pk_bf16_f32 v70, v116, v117
    v_cvt_pk_bf16_f32 v71, v118, v119
    s_mov_b64 exec, s[62:63]
    ds_write_b64 v6, v[64:65] offset:4224
    ds_write_b64 v6, v[66:67] offset:4240
    ds_write_b64 v6, v[68:69] offset:4256
    ds_write_b64 v6, v[70:71] offset:4272
    s_mov_b64 exec, -1
    v_dot2_f32_bf16 v20, v64, v160, 0
    v_dot2_f32_bf16 v20, v65, v161, v20
    v_dot2_f32_bf16 v20, v66, v162, v20
    v_dot2_f32_bf16 v20, v67, v163, v20
    v_dot2_f32_bf16 v20, v68, v164, v20
    v_dot2_f32_bf16 v20, v69, v165, v20
    v_dot2_f32_bf16 v20, v70, v166, v20
    v_dot2_f32_bf16 v20, v71, v167, v20
    v_mov_b64 v[104:105], 0
    v_mov_b64 v[106:107], 0
    v_mov_b64 v[108:109], 0
    v_mov_b64 v[110:111], 0
    v_mov_b64 v[112:113], 0
    v_mov_b64 v[114:115], 0
    v_mov_b64 v[116:117], 0
    v_mov_b64 v[118:119], 0
    s_waitcnt vmcnt(6)
    s_branch K2_next
K2_x2:
    s_add_u32 s54, s56, 270336
    buffer_load_dwordx4 v[220:223], v11, s[24:27], s54 offen offset:0
    buffer_load_dwordx4 v[224:227], v11, s[24:27], s54 offen offset:1024
    buffer_load_dwordx4 v[228:231], v11, s[24:27], s54 offen offset:2048
    buffer_load_dwordx4 v[232:235], v11, s[24:27], s54 offen offset:3072
    v_cvt_pk_bf16_f32 v64, v104, v105
    v_cvt_pk_bf16_f32 v65, v106, v107
    v_cvt_pk_bf16_f32 v66, v108, v109
    v_cvt_pk_bf16_f32 v67, v110, v111
    v_cvt_pk_bf16_f32 v68, v112, v113
    v_cvt_pk_bf16_f32 v69, v114, v115
    v_cvt_pk_bf16_f32 v70, v116, v117
    v_cvt_pk_bf16_f32 v71, v118, v119
    s_mov_b64 exec, s[62:63]
    ds_write_b64 v6, v[64:65] offset:8448
    ds_write_b64 v6, v[66:67] offset:8464
    ds_write_b64 v6, v[68:69] offset:8480
    ds_write_b64 v6, v[70:71] offset:8496
    s_mov_b64 exec, -1
    v_dot2_f32_bf16 v21, v64, v160, 0
    v_dot2_f32_bf16 v21, v65, v161, v21
    v_dot2_f32_bf16 v21, v66, v162, v21
    v_dot2_f32_bf16 v21, v67, v163, v21
    v_dot2_f32_bf16 v21, v68, v164, v21
    v_dot2_f32_bf16 v21, v69, v165, v21
    v_dot2_f32_bf16 v21, v70, v166, v21
    v_dot2_f32_bf16 v21, v71, v167, v21
    v_mov_b64 v[104:105], 0
    v_mov_b64 v[106:107], 0
    v_mov_b64 v[108:109], 0
    v_mov_b64 v[110:111], 0
    v_mov_b64 v[112:113], 0
    v_mov_b64 v[114:115], 0
    v_mov_b64 v[116:117], 0
    v_mov_b64 v[118:119], 0
    s_waitcnt vmcnt(6)
    s_branch K2_next
K2_x3:
    s_add_u32 s54, s56, 274432
    buffer_load_dwordx4 v[236:239], v11, s[24:27], s54 offen offset:0
    buffer_load_dwordx4 v[240:243], v11, s[24:27], s54 offen offset:1024
    buffer_load_dwordx4 v[244:247], v11, s[24:27], s54 offen offset:2048
    buffer_load_dwordx4 v[248:251], v11, s[24:27], s54 offen offset:3072
    v_cvt_pk_bf16_f32 v64, v104, v105
    v_cvt_pk_bf16_f32 v65, v106, v107
    v_cvt_pk_bf16_f32 v66, v108, v109
    v_cvt_pk_bf16_f32 v67, v110, v111
    v_cvt_pk_bf16_f32 v68, v112, v113
    v_cvt_pk_bf16_f32 v69, v114, v115
    v_cvt_pk_bf16_f32 v70, v116, v117
    v_cvt_pk_bf16_f32 v71, v118, v119
    s_mov_b64 exec, s[62:63]
    ds_write_b64 v6, v[64:65] offset:12672
    ds_write_b64 v6, v[66:67] offset:12688
    ds_write_b64 v6, v[68:69] offset:12704
    ds_write_b64 v6, v[70:71] offset:12720
    s_mov_b64 exec, -1
    v_dot2_f32_bf16 v22, v64, v160, 0
    v_dot2_f32_bf16 v22, v65, v161, v22
    v_dot2_f32_bf16 v22, v66, v162, v22
    v_dot2_f32_bf16 v22, v67, v163, v22
    v_dot2_f32_bf16 v22, v68, v164, v22
    v_dot2_f32_bf16 v22, v69, v165, v22
    v_dot2_f32_bf16 v22, v70, v166, v22
    v_dot2_f32_bf16 v22, v71, v167, v22
    v_mov_b64 v[104:105], 0
    v_mov_b64 v[106:107], 0
    v_mov_b64 v[108:109], 0
    v_mov_b64 v[110:111], 0
    v_mov_b64 v[112:113], 0
    v_mov_b64 v[114:115], 0
    v_mov_b64 v[116:117], 0
    v_mov_b64 v[118:119], 0
    s_waitcnt vmcnt(6)
K2_next:
    s_setprio 1
    s_cmp_lt_u32 s44, s41
    s_cbranch_scc1 K2_nf
    s_setprio 2
K2_nf:
    s_add_u32 s42, s42, s42
    s_cbranch_scc1 K2_nextl
    s_cmp_eq_u32 s45, 0
    s_cbranch_scc1 K2_g0
    s_branch K2_g1
K2_nextl:
    s_cmp_eq_u32 s45, 0
    s_cbranch_scc1 K2_l0
    s_branch K2_l1
K2_crest:
    s_lshr_b32 s38, s57, 5
    v_add_u32 v12, s38, v7
    v_add_u32 v13, s38, v8
    s_waitcnt vmcnt(0) lgkmcnt(0)
    buffer_load_dwordx4 v[84:87], v11, s[28:31], s57 offen offset:0
    ds_read_b128 v[88:91], v12 offset:0
    ds_read_b128 v[92:95], v13 offset:0
    s_waitcnt vmcnt(0) lgkmcnt(0)
    v_mfma_f32_32x32x16_bf16 v[168:183], v[84:87], v[88:91], v[168:183]
    v_mfma_f32_16x16x32_bf16 v[184:187], v[84:87], v[92:95], v[184:187]
    s_add_u32 s57, s57, 1024
    s_cmp_lt_u32 s57, 16384
    s_cbranch_scc1 K2_crest
    s_nop 7
    s_branch K2_cdone
K2_nextw:
    s_waitcnt vmcnt(0) lgkmcnt(0)
    s_nop 7
    s_branch K2_next
K2_again1:
    s_waitcnt vmcnt(0)
    s_branch K2_back1
K2_over1:
    s_add_u32 s54, s56, 12288
    buffer_load_dwordx4 v[236:239], v11, s[24:27], s54 offen offset:0
    buffer_load_dwordx4 v[240:243], v11, s[24:27], s54 offen offset:1024
    buffer_load_dwordx4 v[244:247], v11, s[24:27], s54 offen offset:2048
    buffer_load_dwordx4 v[248:251], v11, s[24:27], s54 offen offset:3072
K2_w1d_7:
    s_waitcnt vmcnt(0) lgkmcnt(0)
    s_branch K2_back2
K2_slowstart:
    s_mov_b32 s47, 88
    s_branch K2_setlast
K2_nextpass:
    s_add_u32 s46, s46, 88
K2_setlast:
    s_add_u32 s38, s46, 88
    s_cmp_ge_u32 s38, s50
    s_cselect_b32 s48, 1, 0
    s_waitcnt vmcnt(0) lgkmcnt(0)
    s_barrier
    v_mov_b64 v[64:65], 0
    v_mov_b64 v[66:67], 0
    v_lshlrev_b32 v68, 4, v0
    v_add_u32 v69, 44800, v68
    v_add_u32 v70, 110336, v68
    v_lshlrev_b32 v71, 3, v0
    ds_write_b64 v71, v[64:65] offset:23680
    s_cmp_lg_u32 s37, 0
    s_cbranch_scc1 K2_nolow_8
    ds_write_b128 v68, v[64:67]
K2_nolow_8:
    ds_write_b128 v69, v[64:67] offset:0
    ds_write_b128 v69, v[64:67] offset:8192
    ds_write_b128 v69, v[64:67] offset:16384
    ds_write_b128 v69, v[64:67] offset:24576
    ds_write_b128 v69, v[64:67] offset:32768
    ds_write_b128 v69, v[64:67] offset:40960
    ds_write_b128 v69, v[64:67] offset:49152
    ds_write_b128 v69, v[64:67] offset:57344
    ds_write_b128 v70, v[64:67] offset:0
    ds_write_b128 v70, v[64:67] offset:8192
    ds_write_b128 v70, v[64:67] offset:16384
    s_branch K2_expand
K2_slowflush:
    s_sub_u32 s39, s44, 9
    s_lshl_b32 s54, s2, 3
    s_add_u32 s54, s54, s37
    s_mul_i32 s54, s54, 5
    s_add_u32 s54, s54, s39
    s_lshl_b32 s54, s54, 12
    s_add_u32 s54, s54, 9117696
    buffer_store_dwordx4 v[104:107], v11, s[24:27], s54 offen offset:0 sc1
    buffer_store_dwordx4 v[108:111], v11, s[24:27], s54 offen offset:1024 sc1
    buffer_store_dwordx4 v[112:115], v11, s[24:27], s54 offen offset:2048 sc1
    buffer_store_dwordx4 v[116:119], v11, s[24:27], s54 offen offset:3072 sc1
    s_waitcnt vmcnt(0)
    v_mov_b64 v[104:105], 0
    v_mov_b64 v[106:107], 0
    v_mov_b64 v[108:109], 0
    v_mov_b64 v[110:111], 0
    v_mov_b64 v[112:113], 0
    v_mov_b64 v[114:115], 0
    v_mov_b64 v[116:117], 0
    v_mov_b64 v[118:119], 0
    s_cmp_ge_u32 s44, 13
    s_cbranch_scc1 K2_slowend
    s_cmp_eq_u32 s46, 0
    s_cbranch_scc1 K2_nextw
    s_sub_u32 s39, s44, 8
    s_lshl_b32 s54, s2, 3
    s_add_u32 s54, s54, s37
    s_mul_i32 s54, s54, 5
    s_add_u32 s54, s54, s39
    s_lshl_b32 s54, s54, 12
    s_add_u32 s54, s54, 9117696
    buffer_load_dwordx4 v[104:107], v11, s[24:27], s54 offen offset:0 sc1
    buffer_load_dwordx4 v[108:111], v11, s[24:27], s54 offen offset:1024 sc1
    buffer_load_dwordx4 v[112:115], v11, s[24:27], s54 offen offset:2048 sc1
    buffer_load_dwordx4 v[116:119], v11, s[24:27], s54 offen offset:3072 sc1
    s_waitcnt vmcnt(0)
    s_branch K2_nextw
K2_slowend:
    s_cmp_eq_u32 s48, 0
    s_cbranch_scc1 K2_nextpass
    s_add_u32 s54, s56, 262144
    buffer_load_dwordx4 v[188:191], v11, s[24:27], s54 offen offset:0
    buffer_load_dwordx4 v[192:195], v11, s[24:27], s54 offen offset:1024
    buffer_load_dwordx4 v[196:199], v11, s[24:27], s54 offen offset:2048
    buffer_load_dwordx4 v[200:203], v11, s[24:27], s54 offen offset:3072
    s_add_u32 s54, s56, 266240
    buffer_load_dwordx4 v[204:207], v11, s[24:27], s54 offen offset:0
    buffer_load_dwordx4 v[208:211], v11, s[24:27], s54 offen offset:1024
    buffer_load_dwordx4 v[212:215], v11, s[24:27], s54 offen offset:2048
    buffer_load_dwordx4 v[216:219], v11, s[24:27], s54 offen offset:3072
    s_add_u32 s54, s56, 270336
    buffer_load_dwordx4 v[220:223], v11, s[24:27], s54 offen offset:0
    buffer_load_dwordx4 v[224:227], v11, s[24:27], s54 offen offset:1024
    buffer_load_dwordx4 v[228:231], v11, s[24:27], s54 offen offset:2048
    buffer_load_dwordx4 v[232:235], v11, s[24:27], s54 offen offset:3072
    s_add_u32 s54, s56, 274432
    buffer_load_dwordx4 v[236:239], v11, s[24:27], s54 offen offset:0
    buffer_load_dwordx4 v[240:243], v11, s[24:27], s54 offen offset:1024
    buffer_load_dwordx4 v[244:247], v11, s[24:27], s54 offen offset:2048
    buffer_load_dwordx4 v[248:251], v11, s[24:27], s54 offen offset:3072
    s_mov_b32 s39, 0
    s_lshl_b32 s54, s2, 3
    s_add_u32 s54, s54, s37
    s_mul_i32 s54, s54, 5
    s_add_u32 s54, s54, s39
    s_lshl_b32 s54, s54, 12
    s_add_u32 s54, s54, 9117696
    buffer_load_dwordx4 v[104:107], v11, s[24:27], s54 offen offset:0 sc1
    buffer_load_dwordx4 v[108:111], v11, s[24:27], s54 offen offset:1024 sc1
    buffer_load_dwordx4 v[112:115], v11, s[24:27], s54 offen offset:2048 sc1
    buffer_load_dwordx4 v[116:119], v11, s[24:27], s54 offen offset:3072 sc1
    s_waitcnt vmcnt(0)
    v_cvt_pk_bf16_f32 v64, v104, v105
    v_cvt_pk_bf16_f32 v65, v106, v107
    v_cvt_pk_bf16_f32 v66, v108, v109
    v_cvt_pk_bf16_f32 v67, v110, v111
    v_cvt_pk_bf16_f32 v68, v112, v113
    v_cvt_pk_bf16_f32 v69, v114, v115
    v_cvt_pk_bf16_f32 v70, v116, v117
    v_cvt_pk_bf16_f32 v71, v118, v119
    s_mov_b64 exec, s[62:63]
    ds_write_b64 v6, v[64:65] offset:0
    ds_write_b64 v6, v[66:67] offset:16
    ds_write_b64 v6, v[68:69] offset:32
    ds_write_b64 v6, v[70:71] offset:48
    s_mov_b64 exec, -1
    v_dot2_f32_bf16 v19, v64, v160, 0
    v_dot2_f32_bf16 v19, v65, v161, v19
    v_dot2_f32_bf16 v19, v66, v162, v19
    v_dot2_f32_bf16 v19, v67, v163, v19
    v_dot2_f32_bf16 v19, v68, v164, v19
    v_dot2_f32_bf16 v19, v69, v165, v19
    v_dot2_f32_bf16 v19, v70, v166, v19
    v_dot2_f32_bf16 v19, v71, v167, v19
    v_mov_b64 v[104:105], 0
    v_mov_b64 v[106:107], 0
    v_mov_b64 v[108:109], 0
    v_mov_b64 v[110:111], 0
    v_mov_b64 v[112:113], 0
    v_mov_b64 v[114:115], 0
    v_mov_b64 v[116:117], 0
    v_mov_b64 v[118:119], 0
    s_mov_b32 s39, 1
    s_lshl_b32 s54, s2, 3
    s_add_u32 s54, s54, s37
    s_mul_i32 s54, s54, 5
    s_add_u32 s54, s54, s39
    s_lshl_b32 s54, s54, 12
    s_add_u32 s54, s54, 9117696
    buffer_load_dwordx4 v[104:107], v11, s[24:27], s54 offen offset:0 sc1
    buffer_load_dwordx4 v[108:111], v11, s[24:27], s54 offen offset:1024 sc1
    buffer_load_dwordx4 v[112:115], v11, s[24:27], s54 offen offset:2048 sc1
    buffer_load_dwordx4 v[116:119], v11, s[24:27], s54 offen offset:3072 sc1
    s_waitcnt vmcnt(0)
    v_cvt_pk_bf16_f32 v64, v104, v105
    v_cvt_pk_bf16_f32 v65, v106, v107
    v_cvt_pk_bf16_f32 v66, v108, v109
    v_cvt_pk_bf16_f32 v67, v110, v111
    v_cvt_pk_bf16_f32 v68, v112, v113
    v_cvt_pk_bf16_f32 v69, v114, v115
    v_cvt_pk_bf16_f32 v70, v116, v117
    v_cvt_pk_bf16_f32 v71, v118, v119
    s_mov_b64 exec, s[62:63]
    ds_write_b64 v6, v[64:65] offset:4224
    ds_write_b64 v6, v[66:67] offset:4240
    ds_write_b64 v6, v[68:69] offset:4256
    ds_write_b64 v6, v[70:71] offset:4272
    s_mov_b64 exec, -1
    v_dot2_f32_bf16 v20, v64, v160, 0
    v_dot2_f32_bf16 v20, v65, v161, v20
    v_dot2_f32_bf16 v20, v66, v162, v20
    v_dot2_f32_bf16 v20, v67, v163, v20
    v_dot2_f32_bf16 v20, v68, v164, v20
    v_dot2_f32_bf16 v20, v69, v165, v20
    v_dot2_f32_bf16 v20, v70, v166, v20
    v_dot2_f32_bf16 v20, v71, v167, v20
    v_mov_b64 v[104:105], 0
    v_mov_b64 v[106:107], 0
    v_mov_b64 v[108:109], 0
    v_mov_b64 v[110:111], 0
    v_mov_b64 v[112:113], 0
    v_mov_b64 v[114:115], 0
    v_mov_b64 v[116:117], 0
    v_mov_b64 v[118:119], 0
    s_mov_b32 s39, 2
    s_lshl_b32 s54, s2, 3
    s_add_u32 s54, s54, s37
    s_mul_i32 s54, s54, 5
    s_add_u32 s54, s54, s39
    s_lshl_b32 s54, s54, 12
    s_add_u32 s54, s54, 9117696
    buffer_load_dwordx4 v[104:107], v11, s[24:27], s54 offen offset:0 sc1
    buffer_load_dwordx4 v[108:111], v11, s[24:27], s54 offen offset:1024 sc1
    buffer_load_dwordx4 v[112:115], v11, s[24:27], s54 offen offset:2048 sc1
    buffer_load_dwordx4 v[116:119], v11, s[24:27], s54 offen offset:3072 sc1
    s_waitcnt vmcnt(0)
    v_cvt_pk_bf16_f32 v64, v104, v105
    v_cvt_pk_bf16_f32 v65, v106, v107
    v_cvt_pk_bf16_f32 v66, v108, v109
    v_cvt_pk_bf16_f32 v67, v110, v111
    v_cvt_pk_bf16_f32 v68, v112, v113
    v_cvt_pk_bf16_f32 v69, v114, v115
    v_cvt_pk_bf16_f32 v70, v116, v117
    v_cvt_pk_bf16_f32 v71, v118, v119
    s_mov_b64 exec, s[62:63]
    ds_write_b64 v6, v[64:65] offset:8448
    ds_write_b64 v6, v[66:67] offset:8464
    ds_write_b64 v6, v[68:69] offset:8480
    ds_write_b64 v6, v[70:71] offset:8496
    s_mov_b64 exec, -1
    v_dot2_f32_bf16 v21, v64, v160, 0
    v_dot2_f32_bf16 v21, v65, v161, v21
    v_dot2_f32_bf16 v21, v66, v162, v21
    v_dot2_f32_bf16 v21, v67, v163, v21
    v_dot2_f32_bf16 v21, v68, v164, v21
    v_dot2_f32_bf16 v21, v69, v165, v21
    v_dot2_f32_bf16 v21, v70, v166, v21
    v_dot2_f32_bf16 v21, v71, v167, v21
    v_mov_b64 v[104:105], 0
    v_mov_b64 v[106:107], 0
    v_mov_b64 v[108:109], 0
    v_mov_b64 v[110:111], 0
    v_mov_b64 v[112:113], 0
    v_mov_b64 v[114:115], 0
    v_mov_b64 v[116:117], 0
    v_mov_b64 v[118:119], 0
    s_mov_b32 s39, 3
    s_lshl_b32 s54, s2, 3
    s_add_u32 s54, s54, s37
    s_mul_i32 s54, s54, 5
    s_add_u32 s54, s54, s39
    s_lshl_b32 s54, s54, 12
    s_add_u32 s54, s54, 9117696
    buffer_load_dwordx4 v[104:107], v11, s[24:27], s54 offen offset:0 sc1
    buffer_load_dwordx4 v[108:111], v11, s[24:27], s54 offen offset:1024 sc1
    buffer_load_dwordx4 v[112:115], v11, s[24:27], s54 offen offset:2048 sc1
    buffer_load_dwordx4 v[116:119], v11, s[24:27], s54 offen offset:3072 sc1
    s_waitcnt vmcnt(0)
    v_cvt_pk_bf16_f32 v64, v104, v105
    v_cvt_pk_bf16_f32 v65, v106, v107
    v_cvt_pk_bf16_f32 v66, v108, v109
    v_cvt_pk_bf16_f32 v67, v110, v111
    v_cvt_pk_bf16_f32 v68, v112, v113
    v_cvt_pk_bf16_f32 v69, v114, v115
    v_cvt_pk_bf16_f32 v70, v116, v117
    v_cvt_pk_bf16_f32 v71, v118, v119
    s_mov_b64 exec, s[62:63]
    ds_write_b64 v6, v[64:65] offset:12672
    ds_write_b64 v6, v[66:67] offset:12688
    ds_write_b64 v6, v[68:69] offset:12704
    ds_write_b64 v6, v[70:71] offset:12720
    s_mov_b64 exec, -1
    v_dot2_f32_bf16 v22, v64, v160, 0
    v_dot2_f32_bf16 v22, v65, v161, v22
    v_dot2_f32_bf16 v22, v66, v162, v22
    v_dot2_f32_bf16 v22, v67, v163, v22
    v_dot2_f32_bf16 v22, v68, v164, v22
    v_dot2_f32_bf16 v22, v69, v165, v22
    v_dot2_f32_bf16 v22, v70, v166, v22
    v_dot2_f32_bf16 v22, v71, v167, v22
    v_mov_b64 v[104:105], 0
    v_mov_b64 v[106:107], 0
    v_mov_b64 v[108:109], 0
    v_mov_b64 v[110:111], 0
    v_mov_b64 v[112:113], 0
    v_mov_b64 v[114:115], 0
    v_mov_b64 v[116:117], 0
    v_mov_b64 v[118:119], 0
    s_mov_b32 s39, 4
    s_lshl_b32 s54, s2, 3
    s_add_u32 s54, s54, s37
    s_mul_i32 s54, s54, 5
    s_add_u32 s54, s54, s39
    s_lshl_b32 s54, s54, 12
    s_add_u32 s54, s54, 9117696
    buffer_load_dwordx4 v[104:107], v11, s[24:27], s54 offen offset:0 sc1
    buffer_load_dwordx4 v[108:111], v11, s[24:27], s54 offen offset:1024 sc1
    buffer_load_dwordx4 v[112:115], v11, s[24:27], s54 offen offset:2048 sc1
    buffer_load_dwordx4 v[116:119], v11, s[24:27], s54 offen offset:3072 sc1
    s_waitcnt vmcnt(0)
    s_mov_b32 s44, 5
    s_branch K2_flush2
K2_reload0:
    s_mov_b32 s39, 0
    s_lshl_b32 s54, s2, 3
    s_add_u32 s54, s54, s37
    s_mul_i32 s54, s54, 5
    s_add_u32 s54, s54, s39
    s_lshl_b32 s54, s54, 12
    s_add_u32 s54, s54, 9117696
    buffer_load_dwordx4 v[104:107], v11, s[24:27], s54 offen offset:0 sc1
    buffer_load_dwordx4 v[108:111], v11, s[24:27], s54 offen offset:1024 sc1
    buffer_load_dwordx4 v[112:115], v11, s[24:27], s54 offen offset:2048 sc1
    buffer_load_dwordx4 v[116:119], v11, s[24:27], s54 offen offset:3072 sc1
    s_waitcnt vmcnt(0)
    s_branch K2_back3
.section .rodata,"a"
.p2align 6
.amdhsa_kernel egnn_prep_kernel
  .amdhsa_next_free_vgpr 128
  .amdhsa_next_free_sgpr 64
  .amdhsa_accum_offset 128
  .amdhsa_group_segment_fixed_size 0
  .amdhsa_kernarg_size 88
  .amdhsa_user_sgpr_count 2
  .amdhsa_user_sgpr_kernarg_segment_ptr 1
  .amdhsa_system_sgpr_workgroup_id_x 1
  .amdhsa_float_denorm_mode_32 3
.end_amdhsa_kernel
.p2align 6
.amdhsa_kernel gather_scatter__cheap_equivariant_egnn__graph_kernel
  .amdhsa_next_free_vgpr 256
  .amdhsa_next_free_sgpr 72
  .amdhsa_accum_offset 256
  .amdhsa_group_segment_fixed_size 0
  .amdhsa_kernarg_size 88
  .amdhsa_user_sgpr_count 2
  .amdhsa_user_sgpr_kernarg_segment_ptr 1
  .amdhsa_system_sgpr_workgroup_id_x 1
  .amdhsa_float_denorm_mode_32 3
.end_amdhsa_kernel
```
